```python
import torch

def _softmax(x, axis=-1):
    return torch.softmax(x, dim=axis)

def _gelu(x):
    return torch.nn.functional.gelu(x, approximate='tanh')

def _silu(x):
    return torch.nn.functional.silu(x)

def _sigmoid(x):
    return torch.sigmoid(x)

def _layernorm(x, axis=-1, eps=1e-05):
    m = x.mean(dim=axis, keepdim=True)
    v = x.var(dim=axis, keepdim=True, unbiased=False)
    return (x - m) / torch.sqrt(v + eps)

def _scatter_add(tgt, idx, src, axis=0):
    return tgt.clone().index_add_(axis, idx, src)

def _segment_sum(src, seg, n):
    out = torch.zeros((n,) + src.shape[1:], dtype=src.dtype)
    return out.index_add_(0, seg, src)

def _pad(x, pw):
    flat = tuple((v for pair in reversed(pw) for v in pair))
    return torch.nn.functional.pad(x, flat)
kernel_name = 'adaLN_cond__sliding_block__moe_arch_mod__prompt'

def setup_inputs():

    _w = lambda a: (lambda t: t.to(torch.bfloat16) if t.is_floating_point() else t)(torch.as_tensor(a))

    def _A_setup():
        B, S, D = (1, 2048, 512)
        return {'x': _w((lambda *s: torch.randn(*s, dtype=torch.bfloat16) * 0.05)(B, S, D)), 'wqkv': _w((lambda *s: torch.randn(*s, dtype=torch.bfloat16) * 0.05)(D, 3 * D)), 'wo': _w((lambda *s: torch.randn(*s, dtype=torch.bfloat16) * 0.05)(D, D))}
    _A_in = _A_setup()

    def _B_setup():
        B, S, D, F, C = (1, 2048, 512, 1792, 2)
        return {'x': _w((lambda *s: torch.randn(*s, dtype=torch.bfloat16) * 0.05)(B, S, D)), 'w_r': _w((lambda *s: torch.randn(*s, dtype=torch.bfloat16) * 0.05)(D)), 'w_gate': _w((lambda *s: torch.randn(*s, dtype=torch.bfloat16) * 0.05)(D, F)), 'w_up': _w((lambda *s: torch.randn(*s, dtype=torch.bfloat16) * 0.05)(D, F)), 'w_down': _w((lambda *s: torch.randn(*s, dtype=torch.bfloat16) * 0.05)(F, D))}
    _B_in = _B_setup()
    return {'A_x': _A_in['x'], 'A_wqkv': _A_in['wqkv'], 'A_wo': _A_in['wo'], 'B_x': _B_in['x'], 'B_w_r': _B_in['w_r'], 'B_w_gate': _B_in['w_gate'], 'B_w_up': _B_in['w_up'], 'B_w_down': _B_in['w_down'], 'c': _w((lambda *s: torch.randn(*s, dtype=torch.bfloat16) * 0.1)(1, 512) * 8.0), 'w_mod': _w((lambda *s: torch.randn(*s, dtype=torch.bfloat16) * 0.1)(512, 6 * 512) * 512 ** (-0.5) * 8.0)}

def reference(A_x, A_wqkv, A_wo, B_x, B_w_r, B_w_gate, B_w_up, B_w_down, c, w_mod):

    def _A_ref(x, wqkv, wo):
        B, S, D = x.shape
        H = 32
        Dh = D // H
        W = 256
        qkv = (lambda x, *d: x.permute(*d))((x @ wqkv).reshape(B, S, 3, H, Dh), 2, 0, 3, 1, 4)
        q, k, v = (qkv[0], qkv[1], qkv[2])
        scores = torch.einsum('bhqd,bhkd->bhqk', q, k) * Dh ** (-0.5)
        idx = torch.arange(S)
        mask = (idx[:, None] - idx[None, :] >= 0) & (idx[:, None] - idx[None, :] < W)
        scores = torch.where(mask[None, None], scores, -1000000000.0)
        p = _softmax(scores, axis=-1)
        o = torch.einsum('bhqk,bhkd->bhqd', p, v)
        return (lambda x, *d: x.permute(*d))(o, 0, 2, 1, 3).reshape(B, S, D) @ wo

    def _B_ref(x, w_r, w_gate, w_up, w_down):
        B, S, D = x.shape
        C = 2
        r = x @ w_r
        idx = torch.argsort(-r, axis=-1)[:, :C]
        idx_e = (lambda x, n, axis: torch.repeat_interleave(x, n, dim=axis))(idx.reshape(B, C, 1), D, axis=2)
        x_sel = (lambda x, i, axis: torch.take_along_dim(x, i, dim=axis))(x, idx_e, axis=1)
        g = _silu(x_sel @ w_gate)
        u = x_sel @ w_up
        y = g * u @ w_down
        r_sel = _sigmoid((lambda x, i, axis: torch.take_along_dim(x, i, dim=axis))(r, idx, axis=1))
        y = y * r_sel.reshape(B, C, 1)
        b_off = (torch.arange(B) * S).reshape(B, 1)
        flat_idx = (idx + b_off).reshape(B * C)
        zero = (x * 0.0).reshape(B * S, D)
        upd = _scatter_add(zero, flat_idx, y.reshape(B * C, D), axis=0)
        return x + upd.reshape(B, S, D)
    x = A_x
    mod = (_silu(c) @ w_mod).reshape(c.shape[0], 6, 1, -1)
    sa, ca, ga, sb, cb, gb = (mod[:, 0].clone(), mod[:, 1].clone(), mod[:, 2].clone(), mod[:, 3].clone(), mod[:, 4].clone(), mod[:, 5].clone())
    h = _layernorm(x, axis=-1) * (1 + ca) + sa
    x = x + ga * _A_ref(h, A_wqkv, A_wo)
    h = _layernorm(x, axis=-1) * (1 + cb) + sb
    x = x + gb * _B_ref(h, B_w_r, B_w_gate, B_w_up, B_w_down)
    return x
```

```asm
; @launch grid=(256,1,1) block=(512,1,1) lds=163840
.amdgcn_target "amdgcn-amd-amdhsa--gfx950"
.text
.globl adaLN_cond__sliding_block__moe_arch_mod__prompt_kernel
.p2align 8
.type adaLN_cond__sliding_block__moe_arch_mod__prompt_kernel,@function
adaLN_cond__sliding_block__moe_arch_mod__prompt_kernel:
    s_cmp_ge_u32 s2, 256
    s_cbranch_scc1 L_end
    s_load_dwordx2 s[16:17], s[0:1], 72
    s_load_dwordx2 s[20:21], s[0:1], 64
    v_readfirstlane_b32 s54, v0
    v_and_b32 v1, 63, v0
    s_lshr_b32 s3, s2, 3
    s_lshr_b32 s54, s54, 6
    s_cmp_lg_u32 s54, 1
    s_cbranch_scc1 L_nom1a
    v_lshrrev_b32 v26, 1, v1
    v_mul_u32_u24 v26, 6144, v26
    v_and_b32_e64 v27, 1, v1
    v_lshl_add_u32 v26, v27, 4, v26
    s_lshl_b32 s67, s2, 3
    s_and_b32 s67, s67, 32
    s_add_u32 s67, s67, s3
    s_and_b32 s69, s2, 3
    s_mul_i32 s64, s69, 786432
    s_lshl_b32 s65, s67, 5
    s_add_u32 s64, s64, s65
    s_mov_b32 s18, 0x300000
    s_mov_b32 s19, 0x20000
    s_mov_b32 s22, 0x400
    s_mov_b32 s23, 0x20000
    s_mov_b32 m0, 114688
    v_lshlrev_b32_e64 v27, 2, v1
    s_lshl_b32 s65, s69, 8
    s_waitcnt lgkmcnt(0)
    buffer_load_dword v15, v27, s[20:23], s65 offen
    buffer_load_dwordx4 v26, s[16:19], s64 offen lds
    s_add_u32 m0, m0, 1024
    s_add_u32 s64, s64, 196608
    buffer_load_dwordx4 v26, s[16:19], s64 offen lds
    s_add_u32 m0, m0, 1024
    s_add_u32 s64, s64, 196608
    buffer_load_dwordx4 v26, s[16:19], s64 offen lds
    s_add_u32 m0, m0, 1024
    s_add_u32 s64, s64, 196608
    buffer_load_dwordx4 v26, s[16:19], s64 offen lds
    s_setprio 3
L_nom1a:
    s_load_dwordx2 s[12:13], s[0:1], 96
    s_load_dwordx2 s[4:5], s[0:1], 0
    s_load_dwordx2 s[8:9], s[0:1], 8
    s_getpc_b64 s[48:49]
L_pc:
    s_mov_b32 s50, L_codeend-L_pc
    s_mov_b32 s51, 0x20000
    v_lshrrev_b32 v7, 4, v0
    v_lshlrev_b32 v7, 7, v7
    s_and_b32 s60, s3, 7
    s_lshl_b32 s61, s60, 12
    buffer_load_dword v20, v7, s[48:51], s61 offen
    s_and_b32 s101, s2, 7
    s_and_b32 s52, s101, 3
    s_lshl_b32 s52, s52, 3
    s_add_u32 s52, s52, s60
    s_lshr_b32 s58, s3, 3
    s_and_b32 s53, s101, 4
    s_add_u32 s53, s53, s58
    s_lshl_b32 s66, s58, 1
    s_add_u32 s66, s66, s60
    s_and_b32 s66, s66, 7
    s_mov_b32 s22, 0x400
    s_mov_b32 s23, 0x20000
    s_mov_b32 s18, 0x300000
    s_mov_b32 s19, 0x20000
    s_mov_b32 s6, 0x200000
    s_mov_b32 s7, 0x20000
    s_mov_b32 s14, 0x1000000
    s_mov_b32 s15, 0x20000
    s_mov_b32 s10, 0x180000
    s_mov_b32 s11, 0x20000
    s_waitcnt lgkmcnt(0)
    s_load_dword s94, s[12:13], 0
    v_lshrrev_b32 v22, 4, v1
    v_and_b32 v23, 15, v1
    v_lshrrev_b32 v3, 5, v1
    v_bfe_u32 v26, v1, 2, 3
    v_mul_u32_u24 v6, 3072, v26
    v_lshl_add_u32 v6, v3, 6, v6
    v_and_b32_e64 v26, 3, v1
    v_lshl_add_u32 v6, v26, 4, v6
    s_mul_i32 s100, s54, 24576
    s_lshl_b32 s95, s54, 10
    s_lshl_b32 s63, s53, 7
    s_add_u32 s100, s100, s63
    s_lshl_b32 s62, s66, 7
    v_lshl_add_u32 v24, v23, 4, s62
    v_lshlrev_b32 v25, 10, v22
    s_movk_i32 s63, 0x3ff
    v_and_or_b32 v16, v24, s63, v25
    s_lshl_b32 s61, s52, 16
    s_lshl_b32 s62, s54, 13
    s_add_u32 s61, s61, s62
    s_add_u32 s68, s61, 4096
    v_add_u32 v24, 256, v24
    v_and_or_b32 v17, v24, s63, v25
    v_add_u32 v24, 256, v24
    v_and_or_b32 v18, v24, s63, v25
    v_add_u32 v24, 256, v24
    v_and_or_b32 v19, v24, s63, v25
    buffer_load_dwordx4 v[204:207], v16, s[4:7], s61 offen
    buffer_load_dwordx4 v[208:211], v16, s[4:7], s68 offen
    v_and_b32 v26, 7, v1
    v_mul_u32_u24 v26, 6144, v26
    s_and_b32 s62, s101, 3
    s_lshl_b32 s62, s62, 1
    s_lshr_b32 s63, s101, 2
    s_add_u32 s62, s62, s63
    s_lshl_b32 s62, s62, 3
    s_add_u32 s62, s62, s54
    s_mul_i32 s62, s62, 49152
    s_lshl_b32 s63, s3, 7
    s_add_u32 s62, s62, s63
    s_add_u32 s62, s62, 2048
    buffer_load_dword v21, v26, s[16:19], s62 offen
    s_cmp_lg_u32 s54, 0
    s_cbranch_scc1 L_nmb
    s_lshl_b32 s64, s52, 1
    s_lshr_b32 s62, s53, 2
    s_add_u32 s64, s64, s62
    v_and_b32_e64 v27, 3, v1
    s_lshl_b32 s62, s101, 12
    s_lshl_b32 s63, s3, 7
    s_add_u32 s62, s62, s63
    s_add_u32 s62, s62, 0x8000
    v_mov_b32_e64 v12, s62
    v_bfe_u32 v24, v1, 3, 1
    v_lshlrev_b32_e64 v24, 18, v24
    v_bfe_u32 v25, v1, 2, 1
    v_lshl_add_u32 v24, v25, 11, v24
    v_lshl_add_u32 v24, v27, 7, v24
    s_lshl_b32 s62, s64, 12
    s_lshl_b32 s63, s58, 9
    s_add_u32 s62, s62, s63
    s_add_u32 s69, s62, 0x60000
    v_add_u32 v24, s69, v24
    v_cmp_gt_u32 vcc, 32, v1
    s_nop 1
    v_cndmask_b32 v12, v12, v24, vcc
    s_lshl_b32 s69, s64, 10
    s_add_u32 s69, s69, 982016
    v_lshl_add_u32 v24, v1, 7, s69
    v_cmp_gt_u32 vcc, 16, v1
    s_nop 1
    v_cndmask_b32 v12, v12, v24, vcc
    s_add_u32 s62, s62, s63
    s_add_u32 s62, s62, 0x20000
    v_lshl_add_u32 v24, v1, 7, s62
    v_cmp_gt_u32 vcc, 8, v1
    s_nop 1
    v_cndmask_b32 v12, v12, v24, vcc
    s_lshl_b32 s62, s52, 3
    s_add_u32 s62, s62, s53
    s_lshl_b32 s62, s62, 9
    s_add_u32 s62, s62, 0x1e0000
    v_lshl_add_u32 v24, v27, 7, s62
    v_cmp_lt_u32 vcc, 59, v1
    s_nop 1
    v_cndmask_b32_e64 v12, v12, v24, vcc
    buffer_load_dword v15, v12, s[12:15], 0 offen sc1
L_nmb:
    s_load_dwordx2 s[24:25], s[0:1], 16
    s_load_dwordx2 s[28:29], s[0:1], 32
    s_load_dwordx2 s[32:33], s[0:1], 40
    s_load_dwordx2 s[36:37], s[0:1], 48
    s_load_dwordx2 s[40:41], s[0:1], 56
    s_load_dwordx2 s[44:45], s[0:1], 80
    s_mov_b32 s26, 0x80000
    s_mov_b32 s27, 0x20000
    s_mov_b32 s30, 0x400
    s_mov_b32 s31, 0x20000
    s_mov_b32 s34, 0x1c0000
    s_mov_b32 s35, 0x20000
    s_mov_b32 s38, 0x1c0000
    s_mov_b32 s39, 0x20000
    s_mov_b32 s42, 0x1c0000
    s_mov_b32 s43, 0x20000
    s_mov_b32 s46, 0x200000
    s_mov_b32 s47, 0x20000
    s_lshr_b32 s57, s54, 2
    s_and_b32 s56, s54, 1
    s_lshr_b32 s55, s54, 1
    s_xor_b32 s55, s55, s57
    s_and_b32 s55, s55, 1
    v_lshlrev_b32 v2, 4, v1
    v_and_b32_e64 v4, 31, v1
    v_bfe_u32 v25, v1, 2, 2
    v_lshlrev_b32_e64 v14, 6, v25
    v_bfe_u32 v26, v1, 4, 1
    v_lshl_add_u32 v14, v26, 5, v14
    v_and_b32_e64 v25, 3, v1
    v_lshl_add_u32 v14, v25, 3, v14
    v_lshlrev_b32 v25, 2, v3
    v_sub_u32 v25, v4, v25
    v_mov_b32 v26, 0xff800000
    v_cmp_le_i32_e64 vcc, 0, v25
    v_cmp_le_i32 s[62:63], 1, v25
    s_nop 0
    v_cndmask_b32_e64 v52, v26, 0, vcc
    v_cndmask_b32_e64 v36, 0, v26, vcc
    v_cndmask_b32_e64 v53, v26, 0, s[62:63]
    v_cndmask_b32_e64 v37, 0, v26, s[62:63]
    v_cmp_le_i32 vcc, 2, v25
    v_cmp_le_i32 s[62:63], 3, v25
    s_nop 0
    v_cndmask_b32_e64 v54, v26, 0, vcc
    v_cndmask_b32_e64 v38, 0, v26, vcc
    v_cndmask_b32_e64 v55, v26, 0, s[62:63]
    v_cndmask_b32_e64 v39, 0, v26, s[62:63]
    v_cmp_le_i32 vcc, 8, v25
    v_cmp_le_i32 s[62:63], 9, v25
    s_nop 0
    v_cndmask_b32_e64 v56, v26, 0, vcc
    v_cndmask_b32_e64 v40, 0, v26, vcc
    v_cndmask_b32_e64 v57, v26, 0, s[62:63]
    v_cndmask_b32_e64 v41, 0, v26, s[62:63]
    v_cmp_le_i32 vcc, 10, v25
    v_cmp_le_i32 s[62:63], 11, v25
    s_nop 0
    v_cndmask_b32_e64 v58, v26, 0, vcc
    v_cndmask_b32_e64 v42, 0, v26, vcc
    v_cndmask_b32_e64 v59, v26, 0, s[62:63]
    v_cndmask_b32_e64 v43, 0, v26, s[62:63]
    v_cmp_le_i32 vcc, 16, v25
    v_cmp_le_i32 s[62:63], 17, v25
    s_nop 0
    v_cndmask_b32_e64 v60, v26, 0, vcc
    v_cndmask_b32_e64 v44, 0, v26, vcc
    v_cndmask_b32_e64 v61, v26, 0, s[62:63]
    v_cndmask_b32_e64 v45, 0, v26, s[62:63]
    v_cmp_le_i32 vcc, 18, v25
    v_cmp_le_i32 s[62:63], 19, v25
    s_nop 0
    v_cndmask_b32_e64 v62, v26, 0, vcc
    v_cndmask_b32_e64 v46, 0, v26, vcc
    v_cndmask_b32_e64 v63, v26, 0, s[62:63]
    v_cndmask_b32_e64 v47, 0, v26, s[62:63]
    v_cmp_le_i32 vcc, 24, v25
    v_cmp_le_i32 s[62:63], 25, v25
    s_nop 0
    v_cndmask_b32_e64 v64, v26, 0, vcc
    v_cndmask_b32_e64 v48, 0, v26, vcc
    v_cndmask_b32_e64 v65, v26, 0, s[62:63]
    v_cndmask_b32_e64 v49, 0, v26, s[62:63]
    v_cmp_le_i32 vcc, 26, v25
    v_cmp_le_i32 s[62:63], 27, v25
    s_nop 0
    v_cndmask_b32_e64 v66, v26, 0, vcc
    v_cndmask_b32_e64 v50, 0, v26, vcc
    v_cndmask_b32_e64 v67, v26, 0, s[62:63]
    v_cndmask_b32_e64 v51, 0, v26, s[62:63]
    v_and_b32 v25, 27, v1
    v_cmp_eq_u32_e64 vcc, 16, v25
    v_mov_b32 v26, 0x3f803f80
    s_nop 0
    v_cndmask_b32_e64 v5, 0, v26, vcc
    s_waitcnt lgkmcnt(0)
    s_add_u32 s59, s94, 0x9e3779b1
    s_and_b32 s96, s59, 0xfff
    s_bfe_u32 s97, s59, 0xc000c
    s_lshr_b32 s98, s59, 20
    s_bfe_u32 s99, s59, 0xc0006
    s_lshl_b32 s48, s54, 10
    s_add_u32 s48, s48, 0x1000
    v_and_b32 v25, 7, v1
    v_xor_b32 v25, v25, v22
    v_lshlrev_b32_e64 v25, 4, v25
    v_lshl_add_u32 v25, v23, 9, v25
    s_and_b32 s62, s54, 3
    s_lshl_b32 s62, s62, 7
    s_lshl_b32 s63, s57, 13
    s_add_u32 s62, s62, s63
    s_add_u32 s62, s62, 98304
    v_add_u32 v8, s62, v25
    v_xor_b32 v9, 64, v8
    v_xor_b32 v25, v3, v1
    v_lshlrev_b32_e64 v25, 4, v25
    s_lshl_b32 s62, s55, 13
    s_add_u32 s62, s62, 98304
    v_add_u32_e64 v10, s62, v25
    v_xor_b32 v11, 1056, v10
    v_xor_b32 v12, 2112, v10
    v_xor_b32 v13, 3168, v10
    s_lshl_b32 s62, s56, 9
    v_lshl_add_u32 v28, v3, 10, v14
    v_add_u32 v28, s62, v28
    v_add_u32 v29, 49152, v28
    s_lshl_b32 s62, s56, 2
    s_sub_u32 s62, s62, s66
    s_lshl_b32 s62, s62, 4
    v_add_u32 v25, s62, v1
    v_bfe_u32 v26, v25, 5, 2
    v_lshlrev_b32 v26, 9, v26
    v_and_b32 v27, 1, v25
    v_lshl_add_u32 v26, v27, 8, v26
    v_bfe_u32 v27, v25, 1, 4
    v_lshl_add_u32 v26, v27, 4, v26
    s_lshl_b32 s62, s55, 11
    s_add_u32 s62, s62, 73728
    v_add_u32 v30, s62, v26
    v_lshlrev_b32_e64 v31, 4, v23
    v_add_u32 v31, 73728, v31
    s_cmp_lg_u32 s54, 1
    s_cbranch_scc1 L_nom1b
    v_bfe_u32 v32, v1, 2, 2
    v_lshl_add_u32 v32, v22, 3, v32
    v_and_b32 v27, 3, v1
    v_lshlrev_b32 v27, 3, v27
    v_lshl_add_u32 v32, v32, 5, v27
    v_add_u32 v32, 114688, v32
    v_lshlrev_b32_e64 v33, 4, v22
    v_mov_b32 v27, 0x7ffffff0
    v_cmp_eq_u32 vcc, 0, v23
    s_nop 1
    v_cndmask_b32 v33, v27, v33, vcc
    s_lshl_b32 s64, s69, 12
    s_lshl_b32 s65, s67, 6
    s_add_u32 s64, s64, s65
    s_add_u32 s64, s64, 0x1000
    s_waitcnt vmcnt(8)
    v_lshlrev_b32 v26, 16, v15
    v_and_b32 v27, 0xffff0000, v15
    s_mov_b32 s62, 0xbfb8aa3b
    v_mul_f32 v34, s62, v26
    v_mul_f32 v35, s62, v27
    v_exp_f32 v34, v34
    v_exp_f32 v35, v35
    v_add_f32 v34, 1.0, v34
    v_add_f32 v35, 1.0, v35
    v_rcp_f32 v34, v34
    v_rcp_f32 v35, v35
    v_mul_f32 v26, v26, v34
    v_mul_f32 v27, v27, v35
    v_cvt_pk_bf16_f32 v15, v26, v27
    s_waitcnt lgkmcnt(0)
    s_add_u32 s59, s94, 0x9e3779b1
    s_and_b32 s96, s59, 0xfff
    s_bfe_u32 s97, s59, 0xc000c
    s_lshr_b32 s98, s59, 20
    s_bfe_u32 s99, s59, 0xc0006
    v_lshlrev_b32_e64 v26, 2, v1
    v_add_u32 v26, 131072, v26
    ds_write_b32 v26, v15
    v_lshlrev_b32_e64 v26, 4, v22
    v_add_u32 v26, 131072, v26
    ds_read_b128 v[68:71], v26 offset:0
    ds_read_b128 v[72:75], v26 offset:64
    ds_read_b128 v[76:79], v26 offset:128
    ds_read_b128 v[80:83], v26 offset:192
    s_waitcnt vmcnt(4)
    ds_read_b64_tr_b16 v[84:85], v32 offset:0
    ds_read_b64_tr_b16 v[86:87], v32 offset:128
    ds_read_b64_tr_b16 v[88:89], v32 offset:1024
    ds_read_b64_tr_b16 v[90:91], v32 offset:1152
    ds_read_b64_tr_b16 v[92:93], v32 offset:2048
    ds_read_b64_tr_b16 v[94:95], v32 offset:2176
    ds_read_b64_tr_b16 v[96:97], v32 offset:3072
    ds_read_b64_tr_b16 v[98:99], v32 offset:3200
    s_waitcnt lgkmcnt(6)
    v_mfma_f32_16x16x32_bf16 v[100:103], v[84:87], v[68:71], 0
    s_waitcnt lgkmcnt(4)
    v_mfma_f32_16x16x32_bf16 v[100:103], v[88:91], v[72:75], v[100:103]
    s_waitcnt lgkmcnt(2)
    v_mfma_f32_16x16x32_bf16 v[100:103], v[92:95], v[76:79], v[100:103]
    s_waitcnt lgkmcnt(0)
    v_mfma_f32_16x16x32_bf16 v[100:103], v[96:99], v[80:83], v[100:103]
    v_mov_b32 v25, 0xfffff000
    s_nop 6
    v_add_u32 v100, 0x800, v100
    v_add_u32 v101, 0x800, v101
    v_add_u32 v102, 0x800, v102
    v_add_u32 v103, 0x800, v103
    v_and_or_b32 v100, v100, v25, s96
    v_and_or_b32 v101, v101, v25, s97
    v_and_or_b32 v102, v102, v25, s98
    v_and_or_b32 v103, v103, v25, s99
    buffer_store_dwordx4 v[100:103], v33, s[12:15], s64 offen sc1
L_nom1b:
    s_barrier
L_m1j:
    s_setprio 0
    buffer_load_dwordx4 v[212:215], v17, s[4:7], s61 offen
    buffer_load_dwordx4 v[216:219], v17, s[4:7], s68 offen
    buffer_load_dwordx4 v[220:223], v18, s[4:7], s61 offen
    buffer_load_dwordx4 v[224:227], v18, s[4:7], s68 offen
    buffer_load_dwordx4 v[228:231], v19, s[4:7], s61 offen
    buffer_load_dwordx4 v[232:235], v19, s[4:7], s68 offen
    s_mov_b32 s62, 0x3f803f80
    s_waitcnt vmcnt(8)
    v_dot2_f32_bf16 v33, v204, s62, 0
    v_dot2_f32_bf16 v32, v204, v204, 0
    s_waitcnt vmcnt(7)
    v_dot2_f32_bf16 v35, v208, s62, 0
    v_dot2_f32_bf16 v34, v208, v208, 0
    v_dot2_f32_bf16 v33, v205, s62, v33
    v_dot2_f32_bf16 v32, v205, v205, v32
    v_dot2_f32_bf16 v35, v209, s62, v35
    v_dot2_f32_bf16 v34, v209, v209, v34
    v_dot2_f32_bf16 v33, v206, s62, v33
    v_dot2_f32_bf16 v32, v206, v206, v32
    v_dot2_f32_bf16 v35, v210, s62, v35
    v_dot2_f32_bf16 v34, v210, v210, v34
    v_dot2_f32_bf16 v33, v207, s62, v33
    v_dot2_f32_bf16 v32, v207, v207, v32
    v_dot2_f32_bf16 v35, v211, s62, v35
    v_dot2_f32_bf16 v34, v211, v211, v34
    v_lshlrev_b32_e64 v140, 16, v204
    v_and_b32 v141, 0xffff0000, v204
    v_lshlrev_b32_e64 v142, 16, v205
    v_and_b32 v143, 0xffff0000, v205
    v_lshlrev_b32_e64 v144, 16, v206
    v_and_b32 v145, 0xffff0000, v206
    v_lshlrev_b32_e64 v146, 16, v207
    v_and_b32 v147, 0xffff0000, v207
    v_lshlrev_b32_e64 v148, 16, v208
    v_and_b32 v149, 0xffff0000, v208
    v_lshlrev_b32_e64 v150, 16, v209
    v_and_b32 v151, 0xffff0000, v209
    v_lshlrev_b32_e64 v152, 16, v210
    v_and_b32 v153, 0xffff0000, v210
    v_lshlrev_b32_e64 v154, 16, v211
    v_and_b32 v155, 0xffff0000, v211
    s_waitcnt vmcnt(5)
    v_dot2_f32_bf16 v33, v212, s62, v33
    v_dot2_f32_bf16 v32, v212, v212, v32
    s_waitcnt vmcnt(4)
    v_dot2_f32_bf16 v35, v216, s62, v35
    v_dot2_f32_bf16 v34, v216, v216, v34
    v_dot2_f32_bf16 v33, v213, s62, v33
    v_dot2_f32_bf16 v32, v213, v213, v32
    v_dot2_f32_bf16 v35, v217, s62, v35
    v_dot2_f32_bf16 v34, v217, v217, v34
    v_dot2_f32_bf16 v33, v214, s62, v33
    v_dot2_f32_bf16 v32, v214, v214, v32
    v_dot2_f32_bf16 v35, v218, s62, v35
    v_dot2_f32_bf16 v34, v218, v218, v34
    v_dot2_f32_bf16 v33, v215, s62, v33
    v_dot2_f32_bf16 v32, v215, v215, v32
    v_dot2_f32_bf16 v35, v219, s62, v35
    v_dot2_f32_bf16 v34, v219, v219, v34
    v_lshlrev_b32_e64 v156, 16, v212
    v_and_b32 v157, 0xffff0000, v212
    v_lshlrev_b32_e64 v158, 16, v213
    v_and_b32 v159, 0xffff0000, v213
    v_lshlrev_b32_e64 v160, 16, v214
    v_and_b32 v161, 0xffff0000, v214
    v_lshlrev_b32_e64 v162, 16, v215
    v_and_b32 v163, 0xffff0000, v215
    v_lshlrev_b32_e64 v164, 16, v216
    v_and_b32 v165, 0xffff0000, v216
    v_lshlrev_b32_e64 v166, 16, v217
    v_and_b32 v167, 0xffff0000, v217
    v_lshlrev_b32_e64 v168, 16, v218
    v_and_b32 v169, 0xffff0000, v218
    v_lshlrev_b32_e64 v170, 16, v219
    v_and_b32 v171, 0xffff0000, v219
    s_waitcnt vmcnt(3)
    v_dot2_f32_bf16 v33, v220, s62, v33
    v_dot2_f32_bf16 v32, v220, v220, v32
    s_waitcnt vmcnt(2)
    v_dot2_f32_bf16 v35, v224, s62, v35
    v_dot2_f32_bf16 v34, v224, v224, v34
    v_dot2_f32_bf16 v33, v221, s62, v33
    v_dot2_f32_bf16 v32, v221, v221, v32
    v_dot2_f32_bf16 v35, v225, s62, v35
    v_dot2_f32_bf16 v34, v225, v225, v34
    v_dot2_f32_bf16 v33, v222, s62, v33
    v_dot2_f32_bf16 v32, v222, v222, v32
    v_dot2_f32_bf16 v35, v226, s62, v35
    v_dot2_f32_bf16 v34, v226, v226, v34
    v_dot2_f32_bf16 v33, v223, s62, v33
    v_dot2_f32_bf16 v32, v223, v223, v32
    v_dot2_f32_bf16 v35, v227, s62, v35
    v_dot2_f32_bf16 v34, v227, v227, v34
    v_lshlrev_b32_e64 v172, 16, v220
    v_and_b32 v173, 0xffff0000, v220
    v_lshlrev_b32_e64 v174, 16, v221
    v_and_b32 v175, 0xffff0000, v221
    v_lshlrev_b32_e64 v176, 16, v222
    v_and_b32 v177, 0xffff0000, v222
    v_lshlrev_b32_e64 v178, 16, v223
    v_and_b32 v179, 0xffff0000, v223
    v_lshlrev_b32_e64 v180, 16, v224
    v_and_b32 v181, 0xffff0000, v224
    v_lshlrev_b32_e64 v182, 16, v225
    v_and_b32 v183, 0xffff0000, v225
    v_lshlrev_b32_e64 v184, 16, v226
    v_and_b32 v185, 0xffff0000, v226
    v_lshlrev_b32_e64 v186, 16, v227
    v_and_b32 v187, 0xffff0000, v227
    s_waitcnt vmcnt(1)
    v_dot2_f32_bf16 v33, v228, s62, v33
    v_dot2_f32_bf16 v32, v228, v228, v32
    s_waitcnt vmcnt(0)
    v_dot2_f32_bf16 v35, v232, s62, v35
    v_dot2_f32_bf16 v34, v232, v232, v34
    v_dot2_f32_bf16 v33, v229, s62, v33
    v_dot2_f32_bf16 v32, v229, v229, v32
    v_dot2_f32_bf16 v35, v233, s62, v35
    v_dot2_f32_bf16 v34, v233, v233, v34
    v_dot2_f32_bf16 v33, v230, s62, v33
    v_dot2_f32_bf16 v32, v230, v230, v32
    v_dot2_f32_bf16 v35, v234, s62, v35
    v_dot2_f32_bf16 v34, v234, v234, v34
    v_dot2_f32_bf16 v33, v231, s62, v33
    v_dot2_f32_bf16 v32, v231, v231, v32
    v_dot2_f32_bf16 v35, v235, s62, v35
    v_dot2_f32_bf16 v34, v235, v235, v34
    s_cmp_ge_u32 s54, 4
    s_cbranch_scc1 L_o_1
    s_add_u32 s49, s48, 0
    buffer_load_dwordx4 v[236:239], v2, s[12:15], s49 offen sc1
    s_add_u32 s49, s48, 4096
    buffer_load_dwordx4 v[240:243], v2, s[12:15], s49 offen sc1
    s_add_u32 s49, s48, 8192
    buffer_load_dwordx4 v[244:247], v2, s[12:15], s49 offen sc1
    s_add_u32 s49, s48, 12288
    buffer_load_dwordx4 v[248:251], v2, s[12:15], s49 offen sc1
    s_add_u32 s69, s66, 0
    s_and_b32 s69, s69, 7
    s_mul_i32 s69, s69, 196608
    s_add_u32 s69, s69, s100
    s_add_u32 m0, s95, 0
    s_nop 0
    buffer_load_dwordx4 v6, s[8:11], s69 offen  lds
    s_add_u32 m0, s95, 8192
    s_add_u32 s69, s69, 1024
    buffer_load_dwordx4 v6, s[8:11], s69 offen  lds
    s_add_u32 m0, s95, 16384
    s_add_u32 s69, s69, 1024
    buffer_load_dwordx4 v6, s[8:11], s69 offen  lds
L_o_1:
    v_add_f32_dpp v32, v32, v32 quad_perm:[1,0,3,2] row_mask:0xf bank_mask:0xf
    v_add_f32_dpp v33, v33, v33 quad_perm:[1,0,3,2] row_mask:0xf bank_mask:0xf
    v_add_f32_dpp v34, v34, v34 quad_perm:[1,0,3,2] row_mask:0xf bank_mask:0xf
    v_add_f32_dpp v35, v35, v35 quad_perm:[1,0,3,2] row_mask:0xf bank_mask:0xf
    v_add_f32_dpp v32, v32, v32 quad_perm:[2,3,0,1] row_mask:0xf bank_mask:0xf
    v_add_f32_dpp v33, v33, v33 quad_perm:[2,3,0,1] row_mask:0xf bank_mask:0xf
    v_add_f32_dpp v34, v34, v34 quad_perm:[2,3,0,1] row_mask:0xf bank_mask:0xf
    v_add_f32_dpp v35, v35, v35 quad_perm:[2,3,0,1] row_mask:0xf bank_mask:0xf
    v_add_f32_dpp v32, v32, v32 row_half_mirror row_mask:0xf bank_mask:0xf
    v_add_f32_dpp v33, v33, v33 row_half_mirror row_mask:0xf bank_mask:0xf
    v_add_f32_dpp v34, v34, v34 row_half_mirror row_mask:0xf bank_mask:0xf
    v_add_f32_dpp v35, v35, v35 row_half_mirror row_mask:0xf bank_mask:0xf
    v_add_f32_dpp v32, v32, v32 row_mirror row_mask:0xf bank_mask:0xf
    v_add_f32_dpp v33, v33, v33 row_mirror row_mask:0xf bank_mask:0xf
    v_add_f32_dpp v34, v34, v34 row_mirror row_mask:0xf bank_mask:0xf
    v_add_f32_dpp v35, v35, v35 row_mirror row_mask:0xf bank_mask:0xf
    s_mov_b32 s62, 0x3b000000
    s_mov_b32 s63, 0x3727c5ac
    v_mul_f32 v33, s62, v33
    v_mul_f32 v35, s62, v35
    v_lshlrev_b32 v188, 16, v228
    v_mul_f32 v32, s62, v32
    v_mul_f32_e64 v34, s62, v34
    v_and_b32 v189, 0xffff0000, v228
    v_fma_f32 v32, -v33, v33, v32
    v_fma_f32 v34, -v35, v35, v34
    v_lshlrev_b32 v190, 16, v229
    v_max_f32 v32, 0, v32
    v_max_f32_e64 v34, 0, v34
    v_and_b32 v191, 0xffff0000, v229
    v_cvt_pk_bf16_f32 v32, v33, v32
    v_cvt_pk_bf16_f32 v34, v35, v34
    v_lshlrev_b32 v192, 16, v230
    v_lshlrev_b32 v33, 16, v32
    v_lshlrev_b32_e64 v35, 16, v34
    v_and_b32 v193, 0xffff0000, v230
    v_and_b32 v32, 0xffff0000, v32
    v_and_b32 v34, 0xffff0000, v34
    v_lshlrev_b32 v194, 16, v231
    v_add_f32 v32, s63, v32
    v_add_f32_e64 v34, s63, v34
    v_and_b32 v195, 0xffff0000, v231
    v_cvt_pk_bf16_f32 v32, v32, v32
    v_cvt_pk_bf16_f32 v34, v34, v34
    v_lshlrev_b32_e64 v196, 16, v232
    v_and_b32 v32, 0xffff0000, v32
    v_and_b32 v34, 0xffff0000, v34
    v_and_b32 v197, 0xffff0000, v232
    v_sqrt_f32 v32, v32
    v_sqrt_f32 v34, v34
    v_lshlrev_b32_e64 v198, 16, v233
    v_cvt_pk_bf16_f32 v32, v32, v32
    v_cvt_pk_bf16_f32 v34, v34, v34
    v_and_b32 v199, 0xffff0000, v233
    v_and_b32 v32, 0xffff0000, v32
    v_and_b32 v34, 0xffff0000, v34
    v_lshlrev_b32 v200, 16, v234
    v_rcp_f32 v32, v32
    v_rcp_f32_e64 v34, v34
    v_and_b32 v201, 0xffff0000, v234
    v_lshlrev_b32_e64 v202, 16, v235
    v_and_b32 v203, 0xffff0000, v235
    v_mul_f32 v33, -v33, v32
    v_mul_f32 v35, -v35, v34
    v_pk_fma_f32 v[140:141], v[140:141], v[32:33], v[32:33] op_sel:[0,0,1] op_sel_hi:[1,0,1]
    v_pk_fma_f32 v[142:143], v[142:143], v[32:33], v[32:33] op_sel:[0,0,1] op_sel_hi:[1,0,1]
    v_pk_fma_f32 v[144:145], v[144:145], v[32:33], v[32:33] op_sel:[0,0,1] op_sel_hi:[1,0,1]
    v_pk_fma_f32 v[146:147], v[146:147], v[32:33], v[32:33] op_sel:[0,0,1] op_sel_hi:[1,0,1]
    v_pk_fma_f32 v[148:149], v[148:149], v[34:35], v[34:35] op_sel:[0,0,1] op_sel_hi:[1,0,1]
    v_pk_fma_f32 v[150:151], v[150:151], v[34:35], v[34:35] op_sel:[0,0,1] op_sel_hi:[1,0,1]
    v_pk_fma_f32 v[152:153], v[152:153], v[34:35], v[34:35] op_sel:[0,0,1] op_sel_hi:[1,0,1]
    v_pk_fma_f32 v[154:155], v[154:155], v[34:35], v[34:35] op_sel:[0,0,1] op_sel_hi:[1,0,1]
    v_pk_fma_f32 v[156:157], v[156:157], v[32:33], v[32:33] op_sel:[0,0,1] op_sel_hi:[1,0,1]
    v_pk_fma_f32 v[158:159], v[158:159], v[32:33], v[32:33] op_sel:[0,0,1] op_sel_hi:[1,0,1]
    v_pk_fma_f32 v[160:161], v[160:161], v[32:33], v[32:33] op_sel:[0,0,1] op_sel_hi:[1,0,1]
    v_pk_fma_f32 v[162:163], v[162:163], v[32:33], v[32:33] op_sel:[0,0,1] op_sel_hi:[1,0,1]
    v_pk_fma_f32 v[164:165], v[164:165], v[34:35], v[34:35] op_sel:[0,0,1] op_sel_hi:[1,0,1]
    v_pk_fma_f32 v[166:167], v[166:167], v[34:35], v[34:35] op_sel:[0,0,1] op_sel_hi:[1,0,1]
    v_pk_fma_f32 v[168:169], v[168:169], v[34:35], v[34:35] op_sel:[0,0,1] op_sel_hi:[1,0,1]
    v_pk_fma_f32 v[170:171], v[170:171], v[34:35], v[34:35] op_sel:[0,0,1] op_sel_hi:[1,0,1]
    v_pk_fma_f32 v[172:173], v[172:173], v[32:33], v[32:33] op_sel:[0,0,1] op_sel_hi:[1,0,1]
    v_pk_fma_f32 v[174:175], v[174:175], v[32:33], v[32:33] op_sel:[0,0,1] op_sel_hi:[1,0,1]
    v_pk_fma_f32 v[176:177], v[176:177], v[32:33], v[32:33] op_sel:[0,0,1] op_sel_hi:[1,0,1]
    v_pk_fma_f32 v[178:179], v[178:179], v[32:33], v[32:33] op_sel:[0,0,1] op_sel_hi:[1,0,1]
    v_pk_fma_f32 v[180:181], v[180:181], v[34:35], v[34:35] op_sel:[0,0,1] op_sel_hi:[1,0,1]
    v_pk_fma_f32 v[182:183], v[182:183], v[34:35], v[34:35] op_sel:[0,0,1] op_sel_hi:[1,0,1]
    v_pk_fma_f32 v[184:185], v[184:185], v[34:35], v[34:35] op_sel:[0,0,1] op_sel_hi:[1,0,1]
    v_pk_fma_f32 v[186:187], v[186:187], v[34:35], v[34:35] op_sel:[0,0,1] op_sel_hi:[1,0,1]
    v_pk_fma_f32 v[188:189], v[188:189], v[32:33], v[32:33] op_sel:[0,0,1] op_sel_hi:[1,0,1]
    v_pk_fma_f32 v[190:191], v[190:191], v[32:33], v[32:33] op_sel:[0,0,1] op_sel_hi:[1,0,1]
    v_pk_fma_f32 v[192:193], v[192:193], v[32:33], v[32:33] op_sel:[0,0,1] op_sel_hi:[1,0,1]
    v_pk_fma_f32 v[194:195], v[194:195], v[32:33], v[32:33] op_sel:[0,0,1] op_sel_hi:[1,0,1]
    v_pk_fma_f32 v[196:197], v[196:197], v[34:35], v[34:35] op_sel:[0,0,1] op_sel_hi:[1,0,1]
    v_pk_fma_f32 v[198:199], v[198:199], v[34:35], v[34:35] op_sel:[0,0,1] op_sel_hi:[1,0,1]
    v_pk_fma_f32 v[200:201], v[200:201], v[34:35], v[34:35] op_sel:[0,0,1] op_sel_hi:[1,0,1]
    v_pk_fma_f32 v[202:203], v[202:203], v[34:35], v[34:35] op_sel:[0,0,1] op_sel_hi:[1,0,1]
    s_cmp_ge_u32 s54, 4
    s_cbranch_scc1 L_notab
    s_add_u32 m0, s95, 4096
    s_add_u32 s69, s69, 96256
    buffer_load_dwordx4 v6, s[8:11], s69 offen  lds
    s_add_u32 m0, s95, 12288
    s_add_u32 s69, s69, 1024
    buffer_load_dwordx4 v6, s[8:11], s69 offen  lds
    s_add_u32 m0, s95, 20480
    s_add_u32 s69, s69, 1024
    buffer_load_dwordx4 v6, s[8:11], s69 offen  lds
    s_mov_b32 s68, 0
    s_waitcnt vmcnt(6)
    s_branch L_m1chk
L_m1poll:
    s_add_u32 s49, s48, 0
    buffer_load_dwordx4 v[236:239], v2, s[12:15], s49 offen sc1
    s_add_u32 s49, s48, 4096
    buffer_load_dwordx4 v[240:243], v2, s[12:15], s49 offen sc1
    s_add_u32 s49, s48, 8192
    buffer_load_dwordx4 v[244:247], v2, s[12:15], s49 offen sc1
    s_add_u32 s49, s48, 12288
    buffer_load_dwordx4 v[248:251], v2, s[12:15], s49 offen sc1
    s_waitcnt vmcnt(0)
L_m1chk:
    v_xor_b32 v236, s96, v236
    v_xor_b32 v237, s97, v237
    v_xor_b32 v238, s98, v238
    v_xor_b32 v239, s99, v239
    v_xor_b32 v240, s96, v240
    v_xor_b32 v241, s97, v241
    v_xor_b32 v242, s98, v242
    v_xor_b32 v243, s99, v243
    v_xor_b32 v244, s96, v244
    v_xor_b32 v245, s97, v245
    v_xor_b32 v246, s98, v246
    v_xor_b32 v247, s99, v247
    v_xor_b32 v248, s96, v248
    v_xor_b32 v249, s97, v249
    v_xor_b32 v250, s98, v250
    v_xor_b32_e64 v251, s99, v251
    v_or3_b32 v25, v236, v237, v238
    v_or3_b32 v26, v239, v240, v241
    v_or3_b32 v25, v25, v242, v243
    v_or3_b32 v26, v26, v244, v245
    v_or3_b32 v25, v25, v246, v247
    v_or3_b32 v26, v26, v248, v249
    v_or3_b32 v25, v25, v250, v251
    s_movk_i32 s62, 0xfff
    v_or_b32 v25, v25, v26
    v_and_b32 v25, s62, v25
    v_cmp_ne_u32 vcc, 0, v25
    v_pk_add_f32 v[236:237], v[236:237], v[244:245]
    v_pk_add_f32 v[238:239], v[238:239], v[246:247]
    v_pk_add_f32 v[240:241], v[240:241], v[248:249]
    v_pk_add_f32 v[242:243], v[242:243], v[250:251]
    s_cmp_eq_u64 vcc, 0
    s_cbranch_scc1 L_m1done
    s_add_u32 s68, s68, 1
    s_cmp_lt_u32 s68, 400000
    s_sleep 3
    s_cbranch_scc1 L_m1poll
L_m1done:
    v_pk_add_f32 v[236:237], v[236:237], v[240:241]
    v_pk_add_f32 v[238:239], v[238:239], v[242:243]
    s_cmp_ge_u32 s54, 2
    s_cselect_b32 s63, 1.0, 0
    v_cvt_pk_bf16_f32 v240, v236, v237
    v_cvt_pk_bf16_f32 v241, v238, v239
    v_lshlrev_b32 v236, 16, v240
    v_and_b32 v237, 0xffff0000, v240
    v_lshlrev_b32_e64 v238, 16, v241
    v_and_b32 v239, 0xffff0000, v241
    v_add_f32 v236, s63, v236
    v_add_f32 v237, s63, v237
    v_add_f32 v238, s63, v238
    v_add_f32 v239, s63, v239
    v_cvt_pk_bf16_f32 v240, v236, v237
    v_cvt_pk_bf16_f32 v241, v238, v239
    v_lshlrev_b32_e64 v236, 16, v240
    v_and_b32 v237, 0xffff0000, v240
    v_lshlrev_b32_e64 v238, 16, v241
    v_and_b32 v239, 0xffff0000, v241
    ds_write_b128 v30, v[236:239]
    v_lshlrev_b32 v26, 7, v4
    s_lshl_b32 s62, s3, 2
    s_add_u32 s62, s62, s54
    s_lshl_b32 s62, s62, 12
    buffer_load_dword v20, v26, s[24:27], s62 offen
L_notab:
    s_waitcnt lgkmcnt(0)
    s_barrier
    ds_read_b128 v[68:71], v31 offset:2048
    ds_read_b128 v[76:79], v31 offset:0
    ds_read_b128 v[72:75], v31 offset:2304
    ds_read_b128 v[80:83], v31 offset:256
    ds_read_b128 v[84:87], v31 offset:2560
    ds_read_b128 v[92:95], v31 offset:512
    ds_read_b128 v[88:91], v31 offset:2816
    ds_read_b128 v[96:99], v31 offset:768
    s_waitcnt lgkmcnt(6)
    v_pk_fma_f32 v[140:141], v[140:141], v[68:69], v[76:77]
    v_pk_fma_f32 v[142:143], v[142:143], v[70:71], v[78:79]
    s_waitcnt lgkmcnt(4)
    v_pk_fma_f32 v[144:145], v[144:145], v[72:73], v[80:81]
    v_pk_fma_f32 v[146:147], v[146:147], v[74:75], v[82:83]
    v_pk_fma_f32 v[148:149], v[148:149], v[68:69], v[76:77]
    v_pk_fma_f32 v[150:151], v[150:151], v[70:71], v[78:79]
    v_pk_fma_f32 v[152:153], v[152:153], v[72:73], v[80:81]
    v_pk_fma_f32 v[154:155], v[154:155], v[74:75], v[82:83]
    ds_read_b128 v[100:103], v31 offset:3072
    ds_read_b128 v[108:111], v31 offset:1024
    ds_read_b128 v[104:107], v31 offset:3328
    ds_read_b128 v[112:115], v31 offset:1280
    v_cvt_pk_bf16_f32 v204, v140, v141
    v_cvt_pk_bf16_f32 v205, v142, v143
    v_cvt_pk_bf16_f32 v206, v144, v145
    v_cvt_pk_bf16_f32 v207, v146, v147
    ds_write_b128 v8, v[204:207] offset:49152
    v_cvt_pk_bf16_f32 v208, v148, v149
    v_cvt_pk_bf16_f32 v209, v150, v151
    v_cvt_pk_bf16_f32 v210, v152, v153
    v_cvt_pk_bf16_f32 v211, v154, v155
    ds_write_b128 v9, v[208:211] offset:49152
    s_waitcnt lgkmcnt(8)
    v_pk_fma_f32 v[156:157], v[156:157], v[84:85], v[92:93]
    v_pk_fma_f32 v[158:159], v[158:159], v[86:87], v[94:95]
    s_waitcnt lgkmcnt(6)
    v_pk_fma_f32 v[160:161], v[160:161], v[88:89], v[96:97]
    v_pk_fma_f32 v[162:163], v[162:163], v[90:91], v[98:99]
    v_pk_fma_f32 v[164:165], v[164:165], v[84:85], v[92:93]
    v_pk_fma_f32 v[166:167], v[166:167], v[86:87], v[94:95]
    v_pk_fma_f32 v[168:169], v[168:169], v[88:89], v[96:97]
    v_pk_fma_f32 v[170:171], v[170:171], v[90:91], v[98:99]
    ds_read_b128 v[116:119], v31 offset:3584
    ds_read_b128 v[124:127], v31 offset:1536
    ds_read_b128 v[120:123], v31 offset:3840
    ds_read_b128 v[128:131], v31 offset:1792
    v_cvt_pk_bf16_f32 v212, v156, v157
    v_cvt_pk_bf16_f32 v213, v158, v159
    v_cvt_pk_bf16_f32 v214, v160, v161
    v_cvt_pk_bf16_f32 v215, v162, v163
    ds_write_b128 v8, v[212:215] offset:32768
    v_cvt_pk_bf16_f32 v216, v164, v165
    v_cvt_pk_bf16_f32 v217, v166, v167
    v_cvt_pk_bf16_f32 v218, v168, v169
    v_cvt_pk_bf16_f32 v219, v170, v171
    ds_write_b128 v9, v[216:219] offset:32768
    s_waitcnt lgkmcnt(10)
    v_pk_fma_f32 v[172:173], v[172:173], v[100:101], v[108:109]
    v_pk_fma_f32 v[174:175], v[174:175], v[102:103], v[110:111]
    s_waitcnt lgkmcnt(8)
    v_pk_fma_f32 v[176:177], v[176:177], v[104:105], v[112:113]
    v_pk_fma_f32 v[178:179], v[178:179], v[106:107], v[114:115]
    v_pk_fma_f32 v[180:181], v[180:181], v[100:101], v[108:109]
    v_pk_fma_f32 v[182:183], v[182:183], v[102:103], v[110:111]
    v_pk_fma_f32 v[184:185], v[184:185], v[104:105], v[112:113]
    v_pk_fma_f32 v[186:187], v[186:187], v[106:107], v[114:115]
    v_cvt_pk_bf16_f32 v220, v172, v173
    v_cvt_pk_bf16_f32 v221, v174, v175
    v_cvt_pk_bf16_f32 v222, v176, v177
    v_cvt_pk_bf16_f32 v223, v178, v179
    ds_write_b128 v8, v[220:223] offset:16384
    v_cvt_pk_bf16_f32 v224, v180, v181
    v_cvt_pk_bf16_f32 v225, v182, v183
    v_cvt_pk_bf16_f32 v226, v184, v185
    v_cvt_pk_bf16_f32 v227, v186, v187
    ds_write_b128 v9, v[224:227] offset:16384
    s_add_u32 s69, s66, 1
    s_and_b32 s69, s69, 7
    s_mul_i32 s69, s69, 196608
    s_add_u32 s69, s69, s100
    s_add_u32 m0, s95, 24576
    s_nop 0
    buffer_load_dwordx4 v6, s[8:11], s69 offen  lds
    s_add_u32 m0, s95, 32768
    s_add_u32 s69, s69, 1024
    buffer_load_dwordx4 v6, s[8:11], s69 offen  lds
    s_add_u32 m0, s95, 40960
    s_add_u32 s69, s69, 1024
    buffer_load_dwordx4 v6, s[8:11], s69 offen  lds
    s_waitcnt lgkmcnt(6)
    v_pk_fma_f32 v[188:189], v[188:189], v[116:117], v[124:125]
    v_pk_fma_f32 v[190:191], v[190:191], v[118:119], v[126:127]
    s_waitcnt lgkmcnt(4)
    v_pk_fma_f32 v[192:193], v[192:193], v[120:121], v[128:129]
    v_pk_fma_f32 v[194:195], v[194:195], v[122:123], v[130:131]
    v_pk_fma_f32 v[196:197], v[196:197], v[116:117], v[124:125]
    v_pk_fma_f32 v[198:199], v[198:199], v[118:119], v[126:127]
    v_pk_fma_f32 v[200:201], v[200:201], v[120:121], v[128:129]
    v_pk_fma_f32 v[202:203], v[202:203], v[122:123], v[130:131]
    v_cvt_pk_bf16_f32 v228, v188, v189
    v_cvt_pk_bf16_f32 v229, v190, v191
    v_cvt_pk_bf16_f32 v230, v192, v193
    v_cvt_pk_bf16_f32 v231, v194, v195
    ds_write_b128 v8, v[228:231] offset:0
    v_cvt_pk_bf16_f32 v232, v196, v197
    v_cvt_pk_bf16_f32 v233, v198, v199
    v_cvt_pk_bf16_f32 v234, v200, v201
    v_cvt_pk_bf16_f32 v235, v202, v203
    ds_write_b128 v9, v[232:235] offset:0
    s_add_u32 s69, s66, 2
    s_and_b32 s69, s69, 7
    s_mul_i32 s69, s69, 196608
    s_add_u32 s69, s69, s100
    s_add_u32 m0, s95, 49152
    s_nop 0
    buffer_load_dwordx4 v6, s[8:11], s69 offen  lds
    s_add_u32 m0, s95, 57344
    s_add_u32 s69, s69, 1024
    buffer_load_dwordx4 v6, s[8:11], s69 offen  lds
    s_add_u32 m0, s95, 65536
    s_add_u32 s69, s69, 1024
    buffer_load_dwordx4 v6, s[8:11], s69 offen  lds
    s_cmp_ge_u32 s54, 4
    s_cbranch_scc1 L_hwave
    s_lshl_b32 s65, s56, 1
    s_add_u32 s65, s65, s57
    s_lshl_b32 s62, s55, 2
    s_add_u32 s62, s62, s65
    s_lshl_b32 s64, s52, 3
    s_add_u32 s64, s64, s53
    s_lshl_b32 s67, s64, 9
    s_add_u32 s67, s67, 0x1e0000
    s_lshl_b32 s64, s64, 3
    s_add_u32 s64, s64, s62
    s_mul_i32 s64, s64, 2048
    s_add_u32 s64, s64, 0x200000
    s_mul_i32 s62, s65, 10240
    s_add_u32 s62, s62, 49152
    v_add_u32 v8, s62, v2
    s_lshl_b32 s63, s55, 10
    s_add_u32 s50, s62, s63
    v_add_u32_e64 v18, s50, v2
    s_mul_i32 s62, s56, 20480
    s_add_u32 s62, s62, 90112
    s_lshl_b32 s63, s57, 8
    s_add_u32 s63, s63, s62
    v_add_u32 v9, s63, v2
    s_lshl_b32 s63, s55, 1
    s_add_u32 s63, s63, s57
    s_lshl_b32 s63, s63, 10
    s_add_u32 s51, s62, s63
    v_add_u32_e64 v7, s51, v2
    s_lshl_b32 s62, s55, 1
    s_add_u32 s62, s62, s56
    s_lshl_b32 s62, s62, 10
    s_add_u32 s62, s62, 156160
    v_add_u32 v17, s62, v2
    v_and_b32 v21, 3, v1
    v_sub_u32 v21, 4, v21
    v_cmp_ge_u32 vcc, s52, v21
    v_lshlrev_b32 v21, 12, v21
    s_lshl_b32 s62, s55, 1
    s_add_u32 s62, s62, s56
    s_lshl_b32 s62, s62, 4
    s_add_u32 s62, s62, s57
    s_lshl_b32 s62, s62, 3
    s_add_u32 s62, s62, s67
    v_cndmask_b32 v21, 0, v21, vcc
    v_sub_u32_e64 v21, s62, v21
    v_bfe_u32 v26, v1, 2, 3
    v_lshlrev_b32_e64 v16, 10, v26
    v_lshl_add_u32 v16, v3, 6, v16
    v_and_b32_e64 v26, 3, v1
    v_lshl_add_u32 v16, v26, 4, v16
    v_mov_b32 v124, v5
    v_mov_b32 v125, v5
    v_mov_b32 v126, v5
    v_mov_b32 v127, v5
    v_mov_b32 v128, v5
    v_mov_b32 v129, v5
    v_mov_b32 v130, v5
    v_mov_b32 v131, v5
    v_mov_b32 v132, v5
    v_mov_b32 v133, v5
    v_mov_b32 v134, v5
    v_mov_b32 v135, v5
    v_mov_b32 v136, v5
    v_mov_b32 v137, v5
    v_mov_b32 v138, v5
    v_mov_b32 v139, v5
    s_waitcnt vmcnt(3) lgkmcnt(0)
    s_barrier
    ds_read_b128 v[140:143], v10 offset:49152
    ds_read_b64_tr_b16 v[148:149], v28 offset:8192
    ds_read_b64_tr_b16 v[150:151], v28 offset:8448
    ds_read_b64_tr_b16 v[152:153], v28 offset:16384
    ds_read_b64_tr_b16 v[154:155], v28 offset:16640
    ds_read_b64_tr_b16 v[144:145], v28 offset:0
    ds_read_b64_tr_b16 v[146:147], v28 offset:256
    ds_read_b128 v[156:159], v11 offset:49152
    ds_read_b64_tr_b16 v[164:165], v28 offset:10240
    ds_read_b64_tr_b16 v[166:167], v28 offset:10496
    ds_read_b64_tr_b16 v[168:169], v28 offset:18432
    ds_read_b64_tr_b16 v[170:171], v28 offset:18688
    ds_read_b64_tr_b16 v[160:161], v28 offset:2048
    ds_read_b64_tr_b16 v[162:163], v28 offset:2304
    s_waitcnt lgkmcnt(11)
    v_mfma_f32_32x32x16_bf16 v[84:99], v[148:151], v[140:143], 0
    ds_read_b128 v[172:175], v12 offset:49152
    ds_read_b64_tr_b16 v[180:181], v28 offset:12288
    ds_read_b64_tr_b16 v[182:183], v28 offset:12544
    s_waitcnt lgkmcnt(12)
    v_mfma_f32_32x32x16_bf16 v[100:115], v[140:143], v[152:155], 0
    ds_read_b64_tr_b16 v[184:185], v28 offset:20480
    ds_read_b64_tr_b16 v[186:187], v28 offset:20736
    s_waitcnt lgkmcnt(12)
    v_mfma_f32_32x32x16_bf16 v[68:83], v[144:147], v[140:143], 0
    ds_read_b64_tr_b16 v[176:177], v28 offset:4096
    ds_read_b64_tr_b16 v[178:179], v28 offset:4352
    s_waitcnt lgkmcnt(11)
    v_mfma_f32_32x32x16_bf16 v[84:99], v[164:167], v[156:159], v[84:99]
    ds_read_b128 v[188:191], v13 offset:49152
    ds_read_b64_tr_b16 v[196:197], v28 offset:14336
    ds_read_b64_tr_b16 v[198:199], v28 offset:14592
    s_waitcnt lgkmcnt(12)
    v_mfma_f32_32x32x16_bf16 v[100:115], v[156:159], v[168:171], v[100:115]
    ds_read_b64_tr_b16 v[200:201], v28 offset:22528
    ds_read_b64_tr_b16 v[202:203], v28 offset:22784
    s_waitcnt lgkmcnt(12)
    v_mfma_f32_32x32x16_bf16 v[68:83], v[160:163], v[156:159], v[68:83]
    ds_read_b64_tr_b16 v[192:193], v28 offset:6144
    ds_read_b64_tr_b16 v[194:195], v28 offset:6400
    s_waitcnt lgkmcnt(11)
    v_mfma_f32_32x32x16_bf16 v[84:99], v[180:183], v[172:175], v[84:99]
    ds_read_b128 v[140:143], v10 offset:53248
    ds_read_b64_tr_b16 v[148:149], v28 offset:32768
    ds_read_b64_tr_b16 v[150:151], v28 offset:33024
    s_waitcnt lgkmcnt(12)
    v_mfma_f32_32x32x16_bf16 v[100:115], v[172:175], v[184:187], v[100:115]
    ds_read_b64_tr_b16 v[152:153], v28 offset:40960
    ds_read_b64_tr_b16 v[154:155], v28 offset:41216
    s_waitcnt lgkmcnt(12)
    v_mfma_f32_32x32x16_bf16 v[68:83], v[176:179], v[172:175], v[68:83]
    ds_read_b64_tr_b16 v[144:145], v28 offset:24576
    ds_read_b64_tr_b16 v[146:147], v28 offset:24832
    s_waitcnt lgkmcnt(11)
    v_mfma_f32_32x32x16_bf16 v[84:99], v[196:199], v[188:191], v[84:99]
    ds_read_b128 v[156:159], v11 offset:53248
    ds_read_b64_tr_b16 v[164:165], v28 offset:34816
    ds_read_b64_tr_b16 v[166:167], v28 offset:35072
    s_waitcnt lgkmcnt(12)
    v_mfma_f32_32x32x16_bf16 v[100:115], v[188:191], v[200:203], v[100:115]
    ds_read_b64_tr_b16 v[168:169], v28 offset:43008
    ds_read_b64_tr_b16 v[170:171], v28 offset:43264
    s_waitcnt lgkmcnt(12)
    v_mfma_f32_32x32x16_bf16 v[68:83], v[192:195], v[188:191], v[68:83]
    ds_read_b64_tr_b16 v[160:161], v28 offset:26624
    ds_read_b64_tr_b16 v[162:163], v28 offset:26880
    s_waitcnt vmcnt(0)
    s_barrier
    s_waitcnt lgkmcnt(11)
    v_mfma_f32_32x32x16_bf16 v[84:99], v[148:151], v[140:143], v[84:99]
    ds_read_b128 v[172:175], v12 offset:53248
    ds_read_b64_tr_b16 v[180:181], v28 offset:36864
    ds_read_b64_tr_b16 v[182:183], v28 offset:37120
    s_waitcnt lgkmcnt(12)
    v_mfma_f32_32x32x16_bf16 v[100:115], v[140:143], v[152:155], v[100:115]
    ds_read_b64_tr_b16 v[184:185], v28 offset:45056
    ds_read_b64_tr_b16 v[186:187], v28 offset:45312
    s_waitcnt lgkmcnt(12)
    v_mfma_f32_32x32x16_bf16 v[68:83], v[144:147], v[140:143], v[68:83]
    ds_read_b64_tr_b16 v[176:177], v28 offset:28672
    ds_read_b64_tr_b16 v[178:179], v28 offset:28928
    s_waitcnt lgkmcnt(11)
    v_mfma_f32_32x32x16_bf16 v[84:99], v[164:167], v[156:159], v[84:99]
    ds_read_b128 v[188:191], v13 offset:53248
    ds_read_b64_tr_b16 v[196:197], v28 offset:38912
    ds_read_b64_tr_b16 v[198:199], v28 offset:39168
    s_waitcnt lgkmcnt(12)
    v_mfma_f32_32x32x16_bf16 v[100:115], v[156:159], v[168:171], v[100:115]
    ds_read_b64_tr_b16 v[200:201], v28 offset:47104
    ds_read_b64_tr_b16 v[202:203], v28 offset:47360
    s_waitcnt lgkmcnt(12)
    v_mfma_f32_32x32x16_bf16 v[68:83], v[160:163], v[156:159], v[68:83]
    ds_read_b64_tr_b16 v[192:193], v28 offset:30720
    ds_read_b64_tr_b16 v[194:195], v28 offset:30976
    s_waitcnt lgkmcnt(11)
    v_mfma_f32_32x32x16_bf16 v[84:99], v[180:183], v[172:175], v[84:99]
    ds_read_b128 v[140:143], v10 offset:32768
    ds_read_b64_tr_b16 v[148:149], v29 offset:8192
    ds_read_b64_tr_b16 v[150:151], v29 offset:8448
    s_waitcnt lgkmcnt(12)
    v_mfma_f32_32x32x16_bf16 v[100:115], v[172:175], v[184:187], v[100:115]
    ds_read_b64_tr_b16 v[152:153], v29 offset:16384
    ds_read_b64_tr_b16 v[154:155], v29 offset:16640
    s_waitcnt lgkmcnt(12)
    v_mfma_f32_32x32x16_bf16 v[68:83], v[176:179], v[172:175], v[68:83]
    ds_read_b64_tr_b16 v[144:145], v29 offset:0
    ds_read_b64_tr_b16 v[146:147], v29 offset:256
    s_waitcnt lgkmcnt(11)
    v_mfma_f32_32x32x16_bf16 v[84:99], v[196:199], v[188:191], v[84:99]
    ds_read_b128 v[156:159], v11 offset:32768
    ds_read_b64_tr_b16 v[164:165], v29 offset:10240
    ds_read_b64_tr_b16 v[166:167], v29 offset:10496
    s_waitcnt lgkmcnt(12)
    v_mfma_f32_32x32x16_bf16 v[100:115], v[188:191], v[200:203], v[100:115]
    ds_read_b64_tr_b16 v[168:169], v29 offset:18432
    ds_read_b64_tr_b16 v[170:171], v29 offset:18688
    s_waitcnt lgkmcnt(12)
    v_mfma_f32_32x32x16_bf16 v[68:83], v[192:195], v[188:191], v[68:83]
    ds_read_b64_tr_b16 v[160:161], v29 offset:2048
    ds_read_b64_tr_b16 v[162:163], v29 offset:2304
    s_barrier
    s_waitcnt lgkmcnt(11)
    v_mfma_f32_32x32x16_bf16 v[84:99], v[148:151], v[140:143], v[84:99]
    ds_read_b128 v[172:175], v12 offset:32768
    ds_read_b64_tr_b16 v[180:181], v29 offset:12288
    ds_read_b64_tr_b16 v[182:183], v29 offset:12544
    s_waitcnt lgkmcnt(12)
    v_mfma_f32_32x32x16_bf16 v[100:115], v[140:143], v[152:155], v[100:115]
    ds_read_b64_tr_b16 v[184:185], v29 offset:20480
    ds_read_b64_tr_b16 v[186:187], v29 offset:20736
    s_waitcnt lgkmcnt(12)
    v_mfma_f32_32x32x16_bf16 v[68:83], v[144:147], v[140:143], v[68:83]
    ds_read_b64_tr_b16 v[176:177], v29 offset:4096
    ds_read_b64_tr_b16 v[178:179], v29 offset:4352
    s_waitcnt lgkmcnt(11)
    v_mfma_f32_32x32x16_bf16 v[84:99], v[164:167], v[156:159], v[84:99]
    ds_read_b128 v[188:191], v13 offset:32768
    ds_read_b64_tr_b16 v[196:197], v29 offset:14336
    ds_read_b64_tr_b16 v[198:199], v29 offset:14592
    s_waitcnt lgkmcnt(12)
    v_mfma_f32_32x32x16_bf16 v[100:115], v[156:159], v[168:171], v[100:115]
    ds_read_b64_tr_b16 v[200:201], v29 offset:22528
    ds_read_b64_tr_b16 v[202:203], v29 offset:22784
    s_waitcnt lgkmcnt(12)
    v_mfma_f32_32x32x16_bf16 v[68:83], v[160:163], v[156:159], v[68:83]
    ds_read_b64_tr_b16 v[192:193], v29 offset:6144
    ds_read_b64_tr_b16 v[194:195], v29 offset:6400
    s_waitcnt lgkmcnt(11)
    v_mfma_f32_32x32x16_bf16 v[84:99], v[180:183], v[172:175], v[84:99]
    ds_read_b128 v[140:143], v10 offset:36864
    ds_read_b64_tr_b16 v[148:149], v29 offset:32768
    ds_read_b64_tr_b16 v[150:151], v29 offset:33024
    s_waitcnt lgkmcnt(12)
    v_mfma_f32_32x32x16_bf16 v[100:115], v[172:175], v[184:187], v[100:115]
    ds_read_b64_tr_b16 v[152:153], v29 offset:40960
    ds_read_b64_tr_b16 v[154:155], v29 offset:41216
    s_waitcnt lgkmcnt(12)
    v_mfma_f32_32x32x16_bf16 v[68:83], v[176:179], v[172:175], v[68:83]
    ds_read_b64_tr_b16 v[144:145], v29 offset:24576
    ds_read_b64_tr_b16 v[146:147], v29 offset:24832
    s_waitcnt lgkmcnt(11)
    v_mfma_f32_32x32x16_bf16 v[84:99], v[196:199], v[188:191], v[84:99]
    ds_read_b128 v[156:159], v11 offset:36864
    ds_read_b64_tr_b16 v[164:165], v29 offset:34816
    ds_read_b64_tr_b16 v[166:167], v29 offset:35072
    s_waitcnt lgkmcnt(12)
    v_mfma_f32_32x32x16_bf16 v[100:115], v[188:191], v[200:203], v[100:115]
    ds_read_b64_tr_b16 v[168:169], v29 offset:43008
    ds_read_b64_tr_b16 v[170:171], v29 offset:43264
    s_waitcnt lgkmcnt(12)
    v_mfma_f32_32x32x16_bf16 v[68:83], v[192:195], v[188:191], v[68:83]
    ds_read_b64_tr_b16 v[160:161], v29 offset:26624
    ds_read_b64_tr_b16 v[162:163], v29 offset:26880
    s_barrier
    s_waitcnt lgkmcnt(11)
    v_mfma_f32_32x32x16_bf16 v[84:99], v[148:151], v[140:143], v[84:99]
    ds_read_b128 v[172:175], v12 offset:36864
    ds_read_b64_tr_b16 v[180:181], v29 offset:36864
    ds_read_b64_tr_b16 v[182:183], v29 offset:37120
    s_waitcnt lgkmcnt(12)
    v_mfma_f32_32x32x16_bf16 v[100:115], v[140:143], v[152:155], v[100:115]
    ds_read_b64_tr_b16 v[184:185], v29 offset:45056
    ds_read_b64_tr_b16 v[186:187], v29 offset:45312
    s_waitcnt lgkmcnt(12)
    v_mfma_f32_32x32x16_bf16 v[68:83], v[144:147], v[140:143], v[68:83]
    ds_read_b64_tr_b16 v[176:177], v29 offset:28672
    ds_read_b64_tr_b16 v[178:179], v29 offset:28928
    s_waitcnt lgkmcnt(11)
    v_mfma_f32_32x32x16_bf16 v[84:99], v[164:167], v[156:159], v[84:99]
    ds_read_b128 v[188:191], v13 offset:36864
    ds_read_b64_tr_b16 v[196:197], v29 offset:38912
    ds_read_b64_tr_b16 v[198:199], v29 offset:39168
    s_waitcnt lgkmcnt(12)
    v_mfma_f32_32x32x16_bf16 v[100:115], v[156:159], v[168:171], v[100:115]
    ds_read_b64_tr_b16 v[200:201], v29 offset:47104
    ds_read_b64_tr_b16 v[202:203], v29 offset:47360
    s_waitcnt lgkmcnt(12)
    v_mfma_f32_32x32x16_bf16 v[68:83], v[160:163], v[156:159], v[68:83]
    ds_read_b64_tr_b16 v[192:193], v29 offset:30720
    ds_read_b64_tr_b16 v[194:195], v29 offset:30976
    s_waitcnt lgkmcnt(11)
    v_mfma_f32_32x32x16_bf16 v[84:99], v[180:183], v[172:175], v[84:99]
    ds_read_b128 v[140:143], v10 offset:16384
    ds_read_b64_tr_b16 v[148:149], v28 offset:8192
    ds_read_b64_tr_b16 v[150:151], v28 offset:8448
    s_waitcnt lgkmcnt(12)
    v_mfma_f32_32x32x16_bf16 v[100:115], v[172:175], v[184:187], v[100:115]
    ds_read_b64_tr_b16 v[152:153], v28 offset:16384
    ds_read_b64_tr_b16 v[154:155], v28 offset:16640
    s_waitcnt lgkmcnt(12)
    v_mfma_f32_32x32x16_bf16 v[68:83], v[176:179], v[172:175], v[68:83]
    ds_read_b64_tr_b16 v[144:145], v28 offset:0
    ds_read_b64_tr_b16 v[146:147], v28 offset:256
    s_waitcnt lgkmcnt(11)
    v_mfma_f32_32x32x16_bf16 v[84:99], v[196:199], v[188:191], v[84:99]
    ds_read_b128 v[156:159], v11 offset:16384
    ds_read_b64_tr_b16 v[164:165], v28 offset:10240
    ds_read_b64_tr_b16 v[166:167], v28 offset:10496
    s_waitcnt lgkmcnt(12)
    v_mfma_f32_32x32x16_bf16 v[100:115], v[188:191], v[200:203], v[100:115]
    ds_read_b64_tr_b16 v[168:169], v28 offset:18432
    ds_read_b64_tr_b16 v[170:171], v28 offset:18688
    s_waitcnt lgkmcnt(12)
    v_mfma_f32_32x32x16_bf16 v[68:83], v[192:195], v[188:191], v[68:83]
    ds_read_b64_tr_b16 v[160:161], v28 offset:2048
    ds_read_b64_tr_b16 v[162:163], v28 offset:2304
    s_barrier
    s_waitcnt lgkmcnt(11)
    v_mfma_f32_32x32x16_bf16 v[84:99], v[148:151], v[140:143], v[84:99]
    ds_read_b128 v[172:175], v12 offset:16384
    ds_read_b64_tr_b16 v[180:181], v28 offset:12288
    ds_read_b64_tr_b16 v[182:183], v28 offset:12544
    s_waitcnt lgkmcnt(12)
    v_mfma_f32_32x32x16_bf16 v[100:115], v[140:143], v[152:155], v[100:115]
    ds_read_b64_tr_b16 v[184:185], v28 offset:20480
    ds_read_b64_tr_b16 v[186:187], v28 offset:20736
    s_waitcnt lgkmcnt(12)
    v_mfma_f32_32x32x16_bf16 v[68:83], v[144:147], v[140:143], v[68:83]
    ds_read_b64_tr_b16 v[176:177], v28 offset:4096
    ds_read_b64_tr_b16 v[178:179], v28 offset:4352
    s_waitcnt lgkmcnt(11)
    v_mfma_f32_32x32x16_bf16 v[84:99], v[164:167], v[156:159], v[84:99]
    ds_read_b128 v[188:191], v13 offset:16384
    ds_read_b64_tr_b16 v[196:197], v28 offset:14336
    ds_read_b64_tr_b16 v[198:199], v28 offset:14592
    s_waitcnt lgkmcnt(12)
    v_mfma_f32_32x32x16_bf16 v[100:115], v[156:159], v[168:171], v[100:115]
    ds_read_b64_tr_b16 v[200:201], v28 offset:22528
    ds_read_b64_tr_b16 v[202:203], v28 offset:22784
    s_waitcnt lgkmcnt(12)
    v_mfma_f32_32x32x16_bf16 v[68:83], v[160:163], v[156:159], v[68:83]
    ds_read_b64_tr_b16 v[192:193], v28 offset:6144
    ds_read_b64_tr_b16 v[194:195], v28 offset:6400
    s_waitcnt lgkmcnt(11)
    v_mfma_f32_32x32x16_bf16 v[84:99], v[180:183], v[172:175], v[84:99]
    ds_read_b128 v[140:143], v10 offset:20480
    ds_read_b64_tr_b16 v[148:149], v28 offset:32768
    ds_read_b64_tr_b16 v[150:151], v28 offset:33024
    s_waitcnt lgkmcnt(12)
    v_mfma_f32_32x32x16_bf16 v[100:115], v[172:175], v[184:187], v[100:115]
    ds_read_b64_tr_b16 v[152:153], v28 offset:40960
    ds_read_b64_tr_b16 v[154:155], v28 offset:41216
    s_waitcnt lgkmcnt(12)
    v_mfma_f32_32x32x16_bf16 v[68:83], v[176:179], v[172:175], v[68:83]
    ds_read_b64_tr_b16 v[144:145], v28 offset:24576
    ds_read_b64_tr_b16 v[146:147], v28 offset:24832
    s_waitcnt lgkmcnt(11)
    v_mfma_f32_32x32x16_bf16 v[84:99], v[196:199], v[188:191], v[84:99]
    ds_read_b128 v[156:159], v11 offset:20480
    ds_read_b64_tr_b16 v[164:165], v28 offset:34816
    ds_read_b64_tr_b16 v[166:167], v28 offset:35072
    s_waitcnt lgkmcnt(12)
    v_mfma_f32_32x32x16_bf16 v[100:115], v[188:191], v[200:203], v[100:115]
    ds_read_b64_tr_b16 v[168:169], v28 offset:43008
    ds_read_b64_tr_b16 v[170:171], v28 offset:43264
    s_waitcnt lgkmcnt(12)
    v_mfma_f32_32x32x16_bf16 v[68:83], v[192:195], v[188:191], v[68:83]
    ds_read_b64_tr_b16 v[160:161], v28 offset:26624
    ds_read_b64_tr_b16 v[162:163], v28 offset:26880
    s_barrier
    s_waitcnt lgkmcnt(11)
    v_mfma_f32_32x32x16_bf16 v[84:99], v[148:151], v[140:143], v[84:99]
    ds_read_b128 v[172:175], v12 offset:20480
    ds_read_b64_tr_b16 v[180:181], v28 offset:36864
    ds_read_b64_tr_b16 v[182:183], v28 offset:37120
    s_waitcnt lgkmcnt(12)
    v_mfma_f32_32x32x16_bf16 v[100:115], v[140:143], v[152:155], v[100:115]
    ds_read_b64_tr_b16 v[184:185], v28 offset:45056
    ds_read_b64_tr_b16 v[186:187], v28 offset:45312
    s_waitcnt lgkmcnt(12)
    v_mfma_f32_32x32x16_bf16 v[68:83], v[144:147], v[140:143], v[68:83]
    ds_read_b64_tr_b16 v[176:177], v28 offset:28672
    ds_read_b64_tr_b16 v[178:179], v28 offset:28928
    s_waitcnt lgkmcnt(11)
    v_mfma_f32_32x32x16_bf16 v[84:99], v[164:167], v[156:159], v[84:99]
    ds_read_b128 v[188:191], v13 offset:20480
    ds_read_b64_tr_b16 v[196:197], v28 offset:38912
    ds_read_b64_tr_b16 v[198:199], v28 offset:39168
    s_waitcnt lgkmcnt(12)
    v_mfma_f32_32x32x16_bf16 v[100:115], v[156:159], v[168:171], v[100:115]
    ds_read_b64_tr_b16 v[200:201], v28 offset:47104
    ds_read_b64_tr_b16 v[202:203], v28 offset:47360
    s_waitcnt lgkmcnt(12)
    v_mfma_f32_32x32x16_bf16 v[68:83], v[160:163], v[156:159], v[68:83]
    ds_read_b64_tr_b16 v[192:193], v28 offset:30720
    ds_read_b64_tr_b16 v[194:195], v28 offset:30976
    s_waitcnt lgkmcnt(11)
    v_mfma_f32_32x32x16_bf16 v[84:99], v[180:183], v[172:175], v[84:99]
    ds_read_b128 v[140:143], v10 offset:0
    ds_read_b64_tr_b16 v[148:149], v29 offset:8192
    ds_read_b64_tr_b16 v[150:151], v29 offset:8448
    s_waitcnt lgkmcnt(12)
    v_mfma_f32_32x32x16_bf16 v[100:115], v[172:175], v[184:187], v[100:115]
    ds_read_b64_tr_b16 v[152:153], v29 offset:16384
    ds_read_b64_tr_b16 v[154:155], v29 offset:16640
    s_waitcnt lgkmcnt(12)
    v_mfma_f32_32x32x16_bf16 v[68:83], v[176:179], v[172:175], v[68:83]
    ds_read_b64_tr_b16 v[144:145], v29 offset:0
    ds_read_b64_tr_b16 v[146:147], v29 offset:256
    s_waitcnt lgkmcnt(11)
    v_mfma_f32_32x32x16_bf16 v[84:99], v[196:199], v[188:191], v[84:99]
    ds_read_b128 v[156:159], v11 offset:0
    ds_read_b64_tr_b16 v[164:165], v29 offset:10240
    ds_read_b64_tr_b16 v[166:167], v29 offset:10496
    s_waitcnt lgkmcnt(12)
    v_mfma_f32_32x32x16_bf16 v[100:115], v[188:191], v[200:203], v[100:115]
    ds_read_b64_tr_b16 v[168:169], v29 offset:18432
    ds_read_b64_tr_b16 v[170:171], v29 offset:18688
    s_waitcnt lgkmcnt(12)
    v_mfma_f32_32x32x16_bf16 v[68:83], v[192:195], v[188:191], v[68:83]
    ds_read_b64_tr_b16 v[160:161], v29 offset:2048
    ds_read_b64_tr_b16 v[162:163], v29 offset:2304
    s_barrier
    s_waitcnt lgkmcnt(11)
    v_mfma_f32_32x32x16_bf16 v[84:99], v[148:151], v[140:143], v[84:99]
    ds_read_b128 v[172:175], v12 offset:0
    ds_read_b64_tr_b16 v[180:181], v29 offset:12288
    ds_read_b64_tr_b16 v[182:183], v29 offset:12544
    s_waitcnt lgkmcnt(12)
    v_mfma_f32_32x32x16_bf16 v[100:115], v[140:143], v[152:155], v[100:115]
    ds_read_b64_tr_b16 v[184:185], v29 offset:20480
    ds_read_b64_tr_b16 v[186:187], v29 offset:20736
    s_waitcnt lgkmcnt(12)
    v_mfma_f32_32x32x16_bf16 v[68:83], v[144:147], v[140:143], v[68:83]
    ds_read_b64_tr_b16 v[176:177], v29 offset:4096
    ds_read_b64_tr_b16 v[178:179], v29 offset:4352
    s_waitcnt lgkmcnt(11)
    v_mfma_f32_32x32x16_bf16 v[84:99], v[164:167], v[156:159], v[84:99]
    ds_read_b128 v[188:191], v13 offset:0
    ds_read_b64_tr_b16 v[196:197], v29 offset:14336
    ds_read_b64_tr_b16 v[198:199], v29 offset:14592
    s_waitcnt lgkmcnt(12)
    v_mfma_f32_32x32x16_bf16 v[100:115], v[156:159], v[168:171], v[100:115]
    ds_read_b64_tr_b16 v[200:201], v29 offset:22528
    ds_read_b64_tr_b16 v[202:203], v29 offset:22784
    s_waitcnt lgkmcnt(12)
    v_mfma_f32_32x32x16_bf16 v[68:83], v[160:163], v[156:159], v[68:83]
    ds_read_b64_tr_b16 v[192:193], v29 offset:6144
    ds_read_b64_tr_b16 v[194:195], v29 offset:6400
    s_waitcnt lgkmcnt(11)
    v_mfma_f32_32x32x16_bf16 v[84:99], v[180:183], v[172:175], v[84:99]
    ds_read_b128 v[140:143], v10 offset:4096
    ds_read_b64_tr_b16 v[148:149], v29 offset:32768
    ds_read_b64_tr_b16 v[150:151], v29 offset:33024
    s_waitcnt lgkmcnt(12)
    v_mfma_f32_32x32x16_bf16 v[100:115], v[172:175], v[184:187], v[100:115]
    ds_read_b64_tr_b16 v[152:153], v29 offset:40960
    ds_read_b64_tr_b16 v[154:155], v29 offset:41216
    s_waitcnt lgkmcnt(12)
    v_mfma_f32_32x32x16_bf16 v[68:83], v[176:179], v[172:175], v[68:83]
    ds_read_b64_tr_b16 v[144:145], v29 offset:24576
    ds_read_b64_tr_b16 v[146:147], v29 offset:24832
    s_waitcnt lgkmcnt(11)
    v_mfma_f32_32x32x16_bf16 v[84:99], v[196:199], v[188:191], v[84:99]
    ds_read_b128 v[156:159], v11 offset:4096
    ds_read_b64_tr_b16 v[164:165], v29 offset:34816
    ds_read_b64_tr_b16 v[166:167], v29 offset:35072
    s_waitcnt lgkmcnt(12)
    v_mfma_f32_32x32x16_bf16 v[100:115], v[188:191], v[200:203], v[100:115]
    ds_read_b64_tr_b16 v[168:169], v29 offset:43008
    ds_read_b64_tr_b16 v[170:171], v29 offset:43264
    s_waitcnt lgkmcnt(12)
    v_mfma_f32_32x32x16_bf16 v[68:83], v[192:195], v[188:191], v[68:83]
    ds_read_b64_tr_b16 v[160:161], v29 offset:26624
    ds_read_b64_tr_b16 v[162:163], v29 offset:26880
    s_waitcnt lgkmcnt(11)
    v_mfma_f32_32x32x16_bf16 v[84:99], v[148:151], v[140:143], v[84:99]
    ds_read_b128 v[172:175], v12 offset:4096
    ds_read_b64_tr_b16 v[180:181], v29 offset:36864
    ds_read_b64_tr_b16 v[182:183], v29 offset:37120
    s_waitcnt lgkmcnt(12)
    v_mfma_f32_32x32x16_bf16 v[100:115], v[140:143], v[152:155], v[100:115]
    ds_read_b64_tr_b16 v[184:185], v29 offset:45056
    ds_read_b64_tr_b16 v[186:187], v29 offset:45312
    s_waitcnt lgkmcnt(12)
    v_mfma_f32_32x32x16_bf16 v[68:83], v[144:147], v[140:143], v[68:83]
    ds_read_b64_tr_b16 v[176:177], v29 offset:28672
    ds_read_b64_tr_b16 v[178:179], v29 offset:28928
    s_waitcnt lgkmcnt(11)
    v_mfma_f32_32x32x16_bf16 v[84:99], v[164:167], v[156:159], v[84:99]
    ds_read_b128 v[188:191], v13 offset:4096
    ds_read_b64_tr_b16 v[196:197], v29 offset:38912
    ds_read_b64_tr_b16 v[198:199], v29 offset:39168
    s_waitcnt lgkmcnt(12)
    v_mfma_f32_32x32x16_bf16 v[100:115], v[156:159], v[168:171], v[100:115]
    ds_read_b64_tr_b16 v[200:201], v29 offset:47104
    ds_read_b64_tr_b16 v[202:203], v29 offset:47360
    s_waitcnt lgkmcnt(12)
    v_mfma_f32_32x32x16_bf16 v[68:83], v[160:163], v[156:159], v[68:83]
    ds_read_b64_tr_b16 v[192:193], v29 offset:30720
    ds_read_b64_tr_b16 v[194:195], v29 offset:30976
    s_waitcnt lgkmcnt(11)
    v_mfma_f32_32x32x16_bf16 v[84:99], v[180:183], v[172:175], v[84:99]
    s_waitcnt lgkmcnt(9)
    v_mfma_f32_32x32x16_bf16 v[100:115], v[172:175], v[184:187], v[100:115]
    s_waitcnt lgkmcnt(7)
    v_mfma_f32_32x32x16_bf16 v[68:83], v[176:179], v[172:175], v[68:83]
    s_waitcnt lgkmcnt(4)
    v_mfma_f32_32x32x16_bf16 v[84:99], v[196:199], v[188:191], v[84:99]
    s_waitcnt lgkmcnt(2)
    v_mfma_f32_32x32x16_bf16 v[100:115], v[188:191], v[200:203], v[100:115]
    s_waitcnt lgkmcnt(0)
    v_mfma_f32_32x32x16_bf16 v[68:83], v[192:195], v[188:191], v[68:83]
    s_nop 7
    v_cvt_pk_bf16_f32 v236, v84, v85
    v_cvt_pk_bf16_f32 v237, v86, v87
    v_cvt_pk_bf16_f32 v238, v88, v89
    v_cvt_pk_bf16_f32 v239, v90, v91
    buffer_store_dwordx4 v[236:239], v2, s[12:15], s64 offen offset:0 sc1
    v_cvt_pk_bf16_f32 v244, v92, v93
    v_cvt_pk_bf16_f32 v245, v94, v95
    v_cvt_pk_bf16_f32 v246, v96, v97
    v_cvt_pk_bf16_f32 v247, v98, v99
    buffer_store_dwordx4 v[244:247], v2, s[12:15], s64 offen offset:2048 sc1
    v_cvt_pk_bf16_f32 v240, v100, v101
    v_cvt_pk_bf16_f32 v241, v102, v103
    v_cvt_pk_bf16_f32 v242, v104, v105
    v_cvt_pk_bf16_f32 v243, v106, v107
    buffer_store_dwordx4 v[240:243], v2, s[12:15], s64 offen offset:1024 sc1
    v_cvt_pk_bf16_f32 v248, v108, v109
    v_cvt_pk_bf16_f32 v249, v110, v111
    v_cvt_pk_bf16_f32 v250, v112, v113
    v_cvt_pk_bf16_f32 v251, v114, v115
    buffer_store_dwordx4 v[248:251], v2, s[12:15], s64 offen offset:3072 sc1
    v_add_u32 v25, v236, v240
    v_add_u32 v27, v244, v248
    v_mov_b32 v24, s59
    v_mov_b32 v26, s59
    v_add_u32_dpp v25, v25, v25 quad_perm:[1,0,3,2] row_mask:0xf bank_mask:0xf
    v_add_u32_dpp v27, v27, v27 quad_perm:[1,0,3,2] row_mask:0xf bank_mask:0xf
    s_nop 0
    v_add_u32_dpp v25, v25, v25 quad_perm:[2,3,0,1] row_mask:0xf bank_mask:0xf
    v_add_u32_dpp v27, v27, v27 quad_perm:[2,3,0,1] row_mask:0xf bank_mask:0xf
    s_nop 0
    v_add_u32_dpp v25, v25, v25 row_half_mirror row_mask:0xf bank_mask:0xf
    v_add_u32_dpp v27, v27, v27 row_half_mirror row_mask:0xf bank_mask:0xf
    s_nop 0
    v_add_u32_dpp v25, v25, v25 row_mirror row_mask:0xf bank_mask:0xf
    v_add_u32_dpp v27, v27, v27 row_mirror row_mask:0xf bank_mask:0xf
    v_mov_b32 v30, v25
    v_mov_b32 v31, v27
    s_nop 0
    v_permlane16_swap_b32 v30, v25
    v_permlane16_swap_b32 v31, v27
    v_add_u32 v25, v25, v30
    v_add_u32 v27, v27, v31
    v_mov_b32 v30, v25
    v_mov_b32 v31, v27
    s_nop 0
    v_permlane32_swap_b32 v30, v25
    v_permlane32_swap_b32 v31, v27
    v_add_u32 v25, v25, v30
    v_add_u32 v27, v27, v31
    s_lshl_b32 s62, s54, 7
    v_and_b32 v31, 0x70, v2
    v_add_u32_e64 v31, s62, v31
    buffer_store_dwordx4 v[24:27], v31, s[12:15], s67 offen sc1
    s_barrier
    ds_write_b128 v18, v[236:239] offset:8192
    ds_write_b128 v7, v[240:243] offset:16384
    ds_write_b128 v18, v[244:247] offset:18432
    ds_write_b128 v7, v[248:251] offset:17408
    s_mov_b32 s62, 0x3eb8aa3b
    s_mov_b32 s63, s62
    v_pk_mul_f32 v[76:77], v[76:77], s[62:63]
    v_pk_mul_f32 v[78:79], v[78:79], s[62:63]
    v_pk_mul_f32 v[80:81], v[80:81], s[62:63]
    v_pk_mul_f32 v[82:83], v[82:83], s[62:63]
    v_cvt_pk_bf16_f32 v156, v76, v77
    v_cvt_pk_bf16_f32 v157, v78, v79
    v_cvt_pk_bf16_f32 v158, v80, v81
    v_cvt_pk_bf16_f32 v159, v82, v83
    ds_write_b128 v17, v[156:159]
    v_pk_mul_f32 v[68:69], v[68:69], s[62:63]
    v_pk_mul_f32 v[70:71], v[70:71], s[62:63]
    v_pk_mul_f32 v[72:73], v[72:73], s[62:63]
    v_pk_mul_f32 v[74:75], v[74:75], s[62:63]
    v_cvt_pk_bf16_f32 v32, v68, v69
    v_cvt_pk_bf16_f32 v33, v70, v71
    v_cvt_pk_bf16_f32 v34, v72, v73
    v_cvt_pk_bf16_f32 v35, v74, v75
    s_waitcnt lgkmcnt(0)
    s_barrier
    s_branch L_gjoin
L_hwave:
    s_waitcnt vmcnt(3) lgkmcnt(0)
    s_barrier
    v_bfe_u32 v26, v1, 2, 3
    v_lshlrev_b32 v16, 10, v26
    v_lshl_add_u32 v16, v3, 6, v16
    v_and_b32_e64 v26, 3, v1
    v_lshl_add_u32 v16, v26, 4, v16
    s_add_u32 s69, s66, 3
    s_and_b32 s69, s69, 7
    s_mul_i32 s69, s69, 196608
    s_add_u32 s69, s69, s100
    s_add_u32 m0, s95, 73728
    s_nop 0
    buffer_load_dwordx4 v6, s[8:11], s69 offen  lds
    s_add_u32 m0, s95, 81920
    s_add_u32 s69, s69, 1024
    buffer_load_dwordx4 v6, s[8:11], s69 offen  lds
    s_add_u32 m0, s95, 90112
    s_add_u32 s69, s69, 1024
    buffer_load_dwordx4 v6, s[8:11], s69 offen  lds
    s_add_u32 m0, s95, 69632
    s_add_u32 s69, s69, -100352
    buffer_load_dwordx4 v6, s[8:11], s69 offen  lds
    s_add_u32 m0, s95, 77824
    s_add_u32 s69, s69, 1024
    buffer_load_dwordx4 v6, s[8:11], s69 offen  lds
    s_add_u32 m0, s95, 86016
    s_add_u32 s69, s69, 1024
    buffer_load_dwordx4 v6, s[8:11], s69 offen  lds
    s_waitcnt vmcnt(6)
    s_barrier
    s_add_u32 s69, s66, 4
    s_and_b32 s69, s69, 7
    s_mul_i32 s69, s69, 196608
    s_add_u32 s69, s69, s100
    s_add_u32 m0, s95, 0
    s_nop 0
    buffer_load_dwordx4 v6, s[8:11], s69 offen  lds
    s_add_u32 m0, s95, 8192
    s_add_u32 s69, s69, 1024
    buffer_load_dwordx4 v6, s[8:11], s69 offen  lds
    s_add_u32 m0, s95, 16384
    s_add_u32 s69, s69, 1024
    buffer_load_dwordx4 v6, s[8:11], s69 offen  lds
    s_add_u32 m0, s95, -4096
    s_add_u32 s69, s69, -100352
    buffer_load_dwordx4 v6, s[8:11], s69 offen  lds
    s_add_u32 m0, s95, 4096
    s_add_u32 s69, s69, 1024
    buffer_load_dwordx4 v6, s[8:11], s69 offen  lds
    s_add_u32 m0, s95, 12288
    s_add_u32 s69, s69, 1024
    buffer_load_dwordx4 v6, s[8:11], s69 offen  lds
    s_waitcnt vmcnt(6)
    s_barrier
    s_add_u32 s69, s66, 5
    s_and_b32 s69, s69, 7
    s_mul_i32 s69, s69, 196608
    s_add_u32 s69, s69, s100
    s_add_u32 m0, s95, 24576
    s_nop 0
    buffer_load_dwordx4 v6, s[8:11], s69 offen  lds
    s_add_u32 m0, s95, 32768
    s_add_u32 s69, s69, 1024
    buffer_load_dwordx4 v6, s[8:11], s69 offen  lds
    s_add_u32 m0, s95, 40960
    s_add_u32 s69, s69, 1024
    buffer_load_dwordx4 v6, s[8:11], s69 offen  lds
    s_add_u32 m0, s95, 20480
    s_add_u32 s69, s69, -100352
    buffer_load_dwordx4 v6, s[8:11], s69 offen  lds
    s_add_u32 m0, s95, 28672
    s_add_u32 s69, s69, 1024
    buffer_load_dwordx4 v6, s[8:11], s69 offen  lds
    s_add_u32 m0, s95, 36864
    s_add_u32 s69, s69, 1024
    buffer_load_dwordx4 v6, s[8:11], s69 offen  lds
    s_waitcnt vmcnt(6)
    s_barrier
    s_add_u32 s69, s66, 6
    s_and_b32 s69, s69, 7
    s_mul_i32 s69, s69, 196608
    s_add_u32 s69, s69, s100
    s_add_u32 m0, s95, 49152
    s_nop 0
    buffer_load_dwordx4 v6, s[8:11], s69 offen  lds
    s_add_u32 m0, s95, 57344
    s_add_u32 s69, s69, 1024
    buffer_load_dwordx4 v6, s[8:11], s69 offen  lds
    s_add_u32 m0, s95, 65536
    s_add_u32 s69, s69, 1024
    buffer_load_dwordx4 v6, s[8:11], s69 offen  lds
    s_add_u32 m0, s95, 45056
    s_add_u32 s69, s69, -100352
    buffer_load_dwordx4 v6, s[8:11], s69 offen  lds
    s_add_u32 m0, s95, 53248
    s_add_u32 s69, s69, 1024
    buffer_load_dwordx4 v6, s[8:11], s69 offen  lds
    s_add_u32 m0, s95, 61440
    s_add_u32 s69, s69, 1024
    buffer_load_dwordx4 v6, s[8:11], s69 offen  lds
    s_waitcnt vmcnt(6)
    s_barrier
    s_add_u32 s69, s66, 7
    s_and_b32 s69, s69, 7
    s_mul_i32 s69, s69, 196608
    s_add_u32 s69, s69, s100
    s_add_u32 m0, s95, 73728
    s_nop 0
    buffer_load_dwordx4 v6, s[8:11], s69 offen  lds
    s_add_u32 m0, s95, 81920
    s_add_u32 s69, s69, 1024
    buffer_load_dwordx4 v6, s[8:11], s69 offen  lds
    s_add_u32 m0, s95, 90112
    s_add_u32 s69, s69, 1024
    buffer_load_dwordx4 v6, s[8:11], s69 offen  lds
    s_add_u32 m0, s95, 69632
    s_add_u32 s69, s69, -100352
    buffer_load_dwordx4 v6, s[8:11], s69 offen  lds
    s_add_u32 m0, s95, 77824
    s_add_u32 s69, s69, 1024
    buffer_load_dwordx4 v6, s[8:11], s69 offen  lds
    s_add_u32 m0, s95, 86016
    s_add_u32 s69, s69, 1024
    buffer_load_dwordx4 v6, s[8:11], s69 offen  lds
    s_waitcnt vmcnt(6)
    s_barrier
    s_lshl_b32 s69, s54, 15
    s_lshl_b32 s62, s58, 8
    s_add_u32 s69, s69, s62
    s_add_u32 s69, s69, -131072
    s_lshl_b32 s63, s54, 12
    s_add_u32 m0, s63, 114688
    s_nop 0
    buffer_load_dwordx4 v16, s[24:27], s69 offen lds
    s_add_u32 m0, s63, 115712
    s_add_u32 s69, s69, 8192
    buffer_load_dwordx4 v16, s[24:27], s69 offen lds
    s_add_u32 m0, s63, 116736
    s_add_u32 s69, s69, 8192
    buffer_load_dwordx4 v16, s[24:27], s69 offen lds
    s_add_u32 m0, s63, 117760
    s_add_u32 s69, s69, 8192
    buffer_load_dwordx4 v16, s[24:27], s69 offen lds
    s_waitcnt vmcnt(4)
    s_barrier
    s_lshl_b32 s69, s54, 15
    s_lshl_b32 s62, s58, 8
    s_add_u32 s69, s69, s62
    s_add_u32 s69, s69, -130944
    s_lshl_b32 s63, s54, 12
    s_add_u32 m0, s63, -16384
    s_nop 0
    buffer_load_dwordx4 v16, s[24:27], s69 offen lds
    s_add_u32 m0, s63, -15360
    s_add_u32 s69, s69, 8192
    buffer_load_dwordx4 v16, s[24:27], s69 offen lds
    s_add_u32 m0, s63, -14336
    s_add_u32 s69, s69, 8192
    buffer_load_dwordx4 v16, s[24:27], s69 offen lds
    s_add_u32 m0, s63, -13312
    s_add_u32 s69, s69, 8192
    buffer_load_dwordx4 v16, s[24:27], s69 offen lds
    s_lshl_b32 s69, s54, 15
    s_lshl_b32 s62, s58, 8
    s_add_u32 s69, s69, s62
    s_add_u32 s69, s69, 131072
    s_lshl_b32 s63, s54, 12
    s_add_u32 m0, s63, 0
    s_nop 0
    buffer_load_dwordx4 v16, s[24:27], s69 offen lds
    s_add_u32 m0, s63, 1024
    s_add_u32 s69, s69, 8192
    buffer_load_dwordx4 v16, s[24:27], s69 offen lds
    s_add_u32 m0, s63, 2048
    s_add_u32 s69, s69, 8192
    buffer_load_dwordx4 v16, s[24:27], s69 offen lds
    s_add_u32 m0, s63, 3072
    s_add_u32 s69, s69, 8192
    buffer_load_dwordx4 v16, s[24:27], s69 offen lds
    s_lshl_b32 s69, s54, 15
    s_lshl_b32 s62, s58, 8
    s_add_u32 s69, s69, s62
    s_add_u32 s69, s69, 131200
    s_lshl_b32 s63, s54, 12
    s_add_u32 m0, s63, 16384
    s_nop 0
    buffer_load_dwordx4 v16, s[24:27], s69 offen lds
    s_add_u32 m0, s63, 17408
    s_add_u32 s69, s69, 8192
    buffer_load_dwordx4 v16, s[24:27], s69 offen lds
    s_add_u32 m0, s63, 18432
    s_add_u32 s69, s69, 8192
    buffer_load_dwordx4 v16, s[24:27], s69 offen lds
    s_add_u32 m0, s63, 19456
    s_add_u32 s69, s69, 8192
    buffer_load_dwordx4 v16, s[24:27], s69 offen lds
    v_lshrrev_b32_e64 v26, 3, v1
    v_mul_u32_u24 v26, 6144, v26
    v_and_b32_e64 v27, 7, v1
    v_lshl_add_u32 v26, v27, 4, v26
    s_and_b32 s62, s101, 3
    s_lshl_b32 s62, s62, 1
    s_lshr_b32 s63, s101, 2
    s_add_u32 s62, s62, s63
    s_lshl_b32 s62, s62, 3
    s_add_u32 s62, s62, s54
    s_mul_i32 s62, s62, 49152
    s_lshl_b32 s63, s3, 7
    s_add_u32 s62, s62, s63
    s_add_u32 s62, s62, 2048
    s_add_u32 m0, s95, 147456
    s_nop 0
    buffer_load_dwordx4 v26, s[16:19], s62 offen lds
    s_sub_u32 s62, s62, 196608
    s_add_u32 m0, s95, 143360
    s_nop 0
    buffer_load_dwordx4 v26, s[16:19], s62 offen lds
    s_lshl_b32 s65, s56, 1
    s_add_u32 s65, s65, s57
    s_lshl_b32 s62, s55, 2
    s_add_u32 s62, s62, s65
    s_lshl_b32 s64, s52, 3
    s_add_u32 s64, s64, s53
    s_lshl_b32 s67, s64, 9
    s_add_u32 s67, s67, 0x1e0000
    s_lshl_b32 s64, s64, 3
    s_add_u32 s64, s64, s62
    s_mul_i32 s64, s64, 2048
    s_add_u32 s64, s64, 0x200000
    s_mul_i32 s62, s65, 10240
    s_add_u32 s62, s62, 49152
    v_add_u32 v8, s62, v2
    s_lshl_b32 s63, s55, 10
    s_add_u32 s50, s62, s63
    v_add_u32_e64 v18, s50, v2
    s_mul_i32 s62, s56, 20480
    s_add_u32 s62, s62, 90112
    s_lshl_b32 s63, s57, 8
    s_add_u32 s63, s63, s62
    v_add_u32 v9, s63, v2
    s_lshl_b32 s63, s55, 1
    s_add_u32 s63, s63, s57
    s_lshl_b32 s63, s63, 10
    s_add_u32 s51, s62, s63
    v_add_u32_e64 v7, s51, v2
    s_lshl_b32 s62, s55, 1
    s_add_u32 s62, s62, s56
    s_lshl_b32 s62, s62, 10
    s_add_u32 s62, s62, 156160
    v_add_u32 v17, s62, v2
    v_and_b32 v21, 3, v1
    v_sub_u32 v21, 4, v21
    v_cmp_ge_u32 vcc, s52, v21
    v_lshlrev_b32 v21, 12, v21
    s_lshl_b32 s62, s55, 1
    s_add_u32 s62, s62, s56
    s_lshl_b32 s62, s62, 4
    s_add_u32 s62, s62, s57
    s_lshl_b32 s62, s62, 3
    s_add_u32 s62, s62, s67
    v_cndmask_b32 v21, 0, v21, vcc
    v_sub_u32 v21, s62, v21
    v_mov_b32 v124, v5
    v_mov_b32 v125, v5
    v_mov_b32 v126, v5
    v_mov_b32 v127, v5
    v_mov_b32 v128, v5
    v_mov_b32 v129, v5
    v_mov_b32 v130, v5
    v_mov_b32 v131, v5
    v_mov_b32 v132, v5
    v_mov_b32 v133, v5
    v_mov_b32 v134, v5
    v_mov_b32 v135, v5
    v_mov_b32 v136, v5
    v_mov_b32 v137, v5
    v_mov_b32 v138, v5
    v_mov_b32 v139, v5
    s_barrier
    v_mov_b32 v24, 161792
    v_mov_b32 v26, 0
    v_mov_b32 v27, 0
    ds_write2_b64 v24, v[26:27], v[26:27] offset0:0 offset1:1
    s_waitcnt vmcnt(0) lgkmcnt(0)
    s_barrier
    ds_read_b128 v[32:35], v17
    s_waitcnt lgkmcnt(0)
L_gjoin:
    s_mov_b32 s48, 0x0000ffff
    s_mov_b32 s49, 0x0000ffff
    s_lshl_b32 s62, s55, 11
    v_add_u32_e64 v19, s62, v9
    ds_read_b128 v[140:143], v18 offset:8192
    ds_read_b128 v[144:147], v8 offset:8192
    s_mov_b64 exec, s[48:49]
    ds_read_b128 v[124:127], v19 offset:16384
    ds_read_b128 v[128:131], v19 offset:17408
    s_mov_b64 exec, -1
    s_waitcnt lgkmcnt(3)
    v_mfma_f32_32x32x16_bf16 v[68:83], v[140:143], v[32:35], v[52:67]
    s_nop 11
    v_exp_f32 v68, v68
    v_exp_f32 v69, v69
    v_exp_f32 v70, v70
    v_exp_f32 v71, v71
    v_exp_f32 v72, v72
    v_exp_f32 v73, v73
    v_exp_f32 v74, v74
    v_exp_f32_e64 v75, v75
    s_waitcnt lgkmcnt(2)
    v_mfma_f32_32x32x16_bf16 v[84:99], v[144:147], v[32:35], 0
    s_mov_b64 exec, s[48:49]
    ds_read_b128 v[132:135], v9 offset:16384
    ds_read_b128 v[136:139], v9 offset:17408
    s_mov_b64 exec, -1
    v_cvt_pk_bf16_f32 v116, v68, v69
    v_cvt_pk_bf16_f32 v117, v70, v71
    v_cvt_pk_bf16_f32 v118, v72, v73
    v_cvt_pk_bf16_f32 v119, v74, v75
    v_exp_f32 v76, v76
    v_exp_f32 v77, v77
    v_exp_f32 v78, v78
    v_exp_f32_e64 v79, v79
    s_waitcnt lgkmcnt(3)
    v_mfma_f32_32x32x16_bf16 v[100:115], v[124:127], v[116:119], 0
    v_exp_f32 v80, v80
    v_exp_f32 v81, v81
    v_exp_f32 v82, v82
    v_exp_f32 v83, v83
    v_cvt_pk_bf16_f32 v120, v76, v77
    v_cvt_pk_bf16_f32 v121, v78, v79
    v_cvt_pk_bf16_f32 v122, v80, v81
    v_cvt_pk_bf16_f32 v123, v82, v83
    s_waitcnt lgkmcnt(2)
    s_nop 0
    v_mfma_f32_32x32x16_bf16 v[100:115], v[128:131], v[120:123], v[100:115]
    s_mov_b32 s16, 0
    s_cmp_eq_u32 s55, 0
    s_cbranch_scc1 L_no7a
    v_exp_f32 v84, v84
    v_exp_f32 v85, v85
    v_exp_f32 v86, v86
    v_exp_f32 v87, v87
    v_exp_f32 v88, v88
    v_exp_f32 v89, v89
    v_exp_f32 v90, v90
    v_exp_f32_e64 v91, v91
    v_cvt_pk_bf16_f32 v116, v84, v85
    v_cvt_pk_bf16_f32 v117, v86, v87
    v_cvt_pk_bf16_f32 v118, v88, v89
    v_cvt_pk_bf16_f32 v119, v90, v91
    v_exp_f32 v92, v92
    v_exp_f32 v93, v93
    v_exp_f32 v94, v94
    v_exp_f32_e64 v95, v95
    s_waitcnt lgkmcnt(1)
    v_mfma_f32_32x32x16_bf16 v[100:115], v[132:135], v[116:119], v[100:115]
    v_exp_f32 v96, v96
    v_exp_f32 v97, v97
    v_exp_f32 v98, v98
    v_exp_f32 v99, v99
    v_cvt_pk_bf16_f32 v120, v92, v93
    v_cvt_pk_bf16_f32 v121, v94, v95
    v_cvt_pk_bf16_f32 v122, v96, v97
    v_cvt_pk_bf16_f32 v123, v98, v99
    s_waitcnt lgkmcnt(0)
    s_nop 0
    v_mfma_f32_32x32x16_bf16 v[100:115], v[136:139], v[120:123], v[100:115]
L_no7a:
    s_cmp_eq_u32 s55, 1
    s_cselect_b64 vcc, -1, 0
    v_cndmask_b32 v176, 0, v36, vcc
    v_cndmask_b32 v177, 0, v37, vcc
    v_cndmask_b32 v178, 0, v38, vcc
    v_cndmask_b32 v179, 0, v39, vcc
    v_cndmask_b32 v180, 0, v40, vcc
    v_cndmask_b32 v181, 0, v41, vcc
    v_cndmask_b32 v182, 0, v42, vcc
    v_cndmask_b32 v183, 0, v43, vcc
    v_cndmask_b32 v184, 0, v44, vcc
    v_cndmask_b32 v185, 0, v45, vcc
    v_cndmask_b32 v186, 0, v46, vcc
    v_cndmask_b32 v187, 0, v47, vcc
    v_cndmask_b32 v188, 0, v48, vcc
    v_cndmask_b32 v189, 0, v49, vcc
    v_cndmask_b32 v190, 0, v50, vcc
    v_cndmask_b32_e64 v191, 0, v51, vcc
    s_cmp_eq_u32 s16, 1
    s_cbranch_scc1 L_kvgo
    s_mov_b32 s68, 0
L_kfpoll:
    buffer_load_dwordx2 v[10:11], v21, s[12:15], 0 offen sc1
    s_waitcnt vmcnt(0)
    v_cmp_ne_u32 vcc, s59, v10
    s_nop 0
    s_cmp_eq_u64 vcc, 0
    s_cbranch_scc1 L_kfok
    s_add_u32 s68, s68, 1
    s_cmp_lt_u32 s68, 400000
    s_sleep 3
    s_cbranch_scc1 L_kfpoll
L_kfok:
    s_sub_u32 s62, s64, 131072
    s_cmp_lt_u32 s52, 1
    s_cselect_b32 s62, s64, s62
    s_add_u32 m0, s50, 6144
    s_nop 0
    buffer_load_dwordx4 v2, s[12:15], s62 offen sc1 lds
    s_add_u32 m0, s51, 11264
    s_nop 0
    buffer_load_dwordx4 v2, s[12:15], s62 offen offset:1024 sc1 lds
L_kvgo:
    v_cmp_gt_u32 vcc, 4, v1
    v_sub_u32 v11, 0, v11
    s_mov_b32 s18, 0x00010001
    s_mov_b32 s19, 0x00010001
    v_cndmask_b32 v11, 0, v11, vcc
    s_lshl_b32 s61, s52, 1
    s_lshr_b32 s62, s53, 2
    s_add_u32 s61, s61, s62
    s_and_b32 s62, s54, 3
    s_lshl_b32 s66, s62, 5
    s_lshl_b32 s62, s57, 4
    s_add_u32 s66, s66, s62
    s_lshl_b32 s62, s58, 7
    s_add_u32 s62, s66, s62
    s_lshl_b32 s94, s62, 1
    v_lshlrev_b32 v6, 4, v4
    v_lshl_add_u32 v6, v3, 13, v6
    s_lshl_b32 s21, s57, 1
    s_add_u32 s21, s21, s56
    s_lshl_b32 s62, s21, 11
    s_lshl_b32 s63, s58, 9
    s_add_u32 s62, s62, s63
    s_add_u32 s67, s62, 0xe0000
    v_lshl_add_u32 v13, v3, 8, v14
    s_lshl_b32 s63, s56, 9
    v_add_u32_e64 v13, s63, v13
    s_lshr_b32 s62, s54, 1
    s_lshl_b32 s62, s62, 14
    s_sub_u32 s63, s62, 16384
    s_cmp_eq_u32 s62, 0
    s_cselect_b32 s63, 131072, s63
    v_add_u32 v13, s63, v13
    s_mul_i32 s100, s101, 14
    s_add_u32 s100, s100, s3
    v_lshrrev_b32_e64 v17, 1, v1
    v_mul_u32_u24 v17, 3584, v17
    v_and_b32_e64 v25, 1, v1
    v_lshl_add_u32 v17, v25, 4, v17
    s_mul_i32 s65, s54, 229376
    s_lshl_b32 s63, s100, 5
    s_add_u32 s65, s65, s63
    s_lshl_b32 s95, s54, 11
    s_lshl_b32 s0, s100, 14
    s_add_u32 s0, s0, s95
    s_bitcmp1_b32 s100, 1
    s_cselect_b64 s[62:63], s[36:37], s[32:33]
    s_cselect_b64 s[36:37], s[32:33], s[36:37]
    s_mov_b64 s[32:33], s[62:63]
    s_cselect_b32 s62, 16384, 0
    s_and_b32 s63, s100, 1
    s_lshl_b32 s69, s63, 10
    s_add_u32 s62, s62, s69
    s_add_u32 s60, s62, s95
    s_add_u32 s60, s60, 98304
    s_mul_i32 s63, s63, 114688
    s_add_u32 s20, s65, 114688
    s_sub_u32 s20, s20, s63
    s_add_u32 s65, s65, s63
    s_lshl_b32 s22, s57, 18
    s_lshl_b32 s62, s56, 16
    s_add_u32 s22, s22, s62
    s_bfe_u32 s62, s54, 0x10001
    s_lshl_b32 s62, s62, 7
    s_add_u32 s22, s22, s62
    s_lshl_b32 s62, s58, 8
    s_add_u32 s22, s22, s62
    s_lshl_b32 s23, s54, 13
    s_cmp_lt_u32 s54, 2
    s_cselect_b32 s62, 147456, 0
    s_add_u32 s23, s23, s62
    s_sub_u32 s23, s23, 16384
    s_cmp_lg_u32 s54, 0
    s_cbranch_scc1 L_nts
    v_lshrrev_b32 v30, 2, v1
    v_mul_u32_u24 v30, 3584, v30
    v_and_b32_e64 v27, 3, v1
    v_lshl_add_u32 v30, v27, 7, v30
    s_mul_i32 s8, s3, 57344
    s_mul_i32 s69, s101, 448
    s_and_b32 s69, s69, 0xffffff80
    s_add_u32 s8, s8, s69
    v_min_u32 v31, 55, v1
    v_lshlrev_b32_e64 v31, 7, v31
    s_lshl_b32 s62, s101, 5
    s_add_u32 s62, s62, s3
    s_mul_i32 s9, s62, 7168
L_nts:
    s_sub_u32 s62, s64, 262144
    s_cmp_lt_u32 s52, 2
    s_cselect_b32 s62, s64, s62
    s_add_u32 m0, s50, 4096
    s_nop 0
    buffer_load_dwordx4 v2, s[12:15], s62 offen sc1 lds
    s_add_u32 m0, s51, 7168
    s_nop 0
    buffer_load_dwordx4 v2, s[12:15], s62 offen offset:1024 sc1 lds
    s_sub_u32 s62, s64, 393216
    s_cmp_lt_u32 s52, 3
    s_cselect_b32 s62, s64, s62
    s_add_u32 m0, s50, 2048
    s_nop 0
    buffer_load_dwordx4 v2, s[12:15], s62 offen sc1 lds
    s_add_u32 m0, s51, 3072
    s_nop 0
    buffer_load_dwordx4 v2, s[12:15], s62 offen offset:1024 sc1 lds
    s_sub_u32 s62, s64, 524288
    s_cmp_lt_u32 s52, 4
    s_cselect_b32 s62, s64, s62
    s_add_u32 m0, s50, 0
    s_nop 0
    buffer_load_dwordx4 v2, s[12:15], s62 offen sc1 lds
    s_add_u32 m0, s51, -1024
    s_nop 0
    buffer_load_dwordx4 v2, s[12:15], s62 offen offset:1024 sc1 lds
    s_cmp_lg_u32 s54, 1
    s_cbranch_scc1 L_nm2d
    s_lshr_b32 s63, s101, 2
    s_lshl_b32 s62, s63, 7
    v_lshlrev_b32 v26, 2, v1
    v_add_u32 v26, 155648, v26
    ds_write_b32 v26, v15
    v_lshlrev_b32_e64 v26, 4, v22
    v_add_u32 v26, 155648, v26
    v_add_u32_e64 v26, s62, v26
    ds_read_b128 v[224:227], v26 offset:0
    ds_read_b128 v[228:231], v26 offset:64
    v_bfe_u32 v30, v1, 2, 2
    v_lshl_add_u32 v30, v22, 3, v30
    v_and_b32 v27, 3, v1
    v_lshlrev_b32 v27, 3, v27
    v_lshl_add_u32 v30, v30, 7, v27
    v_add_u32 v30, 147456, v30
    v_lshlrev_b32_e64 v31, 4, v22
    v_mov_b32 v27, 0x7ffffff0
    v_cmp_eq_u32 vcc, 0, v23
    s_nop 1
    v_cndmask_b32_e64 v31, v27, v31, vcc
    s_and_b32 s62, s101, 3
    s_lshl_b32 s62, s62, 1
    s_add_u32 s62, s62, s63
    s_lshl_b32 s62, s62, 13
    s_lshl_b32 s63, s3, 8
    s_add_u32 s62, s62, s63
    s_add_u32 s62, s62, 0xe0000
    ds_read_b64_tr_b16 v[192:193], v30 offset:0
    ds_read_b64_tr_b16 v[194:195], v30 offset:512
    ds_read_b64_tr_b16 v[196:197], v30 offset:4096
    ds_read_b64_tr_b16 v[198:199], v30 offset:4608
    ds_read_b64_tr_b16 v[200:201], v30 offset:32
    ds_read_b64_tr_b16 v[202:203], v30 offset:544
    ds_read_b64_tr_b16 v[204:205], v30 offset:4128
    ds_read_b64_tr_b16 v[206:207], v30 offset:4640
    ds_read_b64_tr_b16 v[208:209], v30 offset:64
    ds_read_b64_tr_b16 v[210:211], v30 offset:576
    ds_read_b64_tr_b16 v[212:213], v30 offset:4160
    ds_read_b64_tr_b16 v[214:215], v30 offset:4672
    ds_read_b64_tr_b16 v[216:217], v30 offset:96
    ds_read_b64_tr_b16 v[218:219], v30 offset:608
    ds_read_b64_tr_b16 v[220:221], v30 offset:4192
    ds_read_b64_tr_b16 v[222:223], v30 offset:4704
    s_waitcnt lgkmcnt(14)
    v_mfma_f32_16x16x32_bf16 v[232:235], v[192:195], v[224:227], 0
    s_waitcnt lgkmcnt(10)
    v_mfma_f32_16x16x32_bf16 v[236:239], v[200:203], v[224:227], 0
    s_waitcnt lgkmcnt(6)
    v_mfma_f32_16x16x32_bf16 v[240:243], v[208:211], v[224:227], 0
    s_waitcnt lgkmcnt(2)
    v_mfma_f32_16x16x32_bf16 v[244:247], v[216:219], v[224:227], 0
    v_mfma_f32_16x16x32_bf16 v[232:235], v[196:199], v[228:231], v[232:235]
    v_mfma_f32_16x16x32_bf16 v[236:239], v[204:207], v[228:231], v[236:239]
    v_mfma_f32_16x16x32_bf16 v[240:243], v[212:215], v[228:231], v[240:243]
    s_waitcnt lgkmcnt(0)
    v_mfma_f32_16x16x32_bf16 v[244:247], v[220:223], v[228:231], v[244:247]
    v_mov_b32 v25, 0xfffff000
    s_nop 2
    v_add_u32 v232, 0x800, v232
    v_add_u32 v233, 0x800, v233
    v_add_u32 v234, 0x800, v234
    v_add_u32 v235, 0x800, v235
    v_and_or_b32 v232, v232, v25, s96
    v_and_or_b32 v233, v233, v25, s97
    v_and_or_b32 v234, v234, v25, s98
    v_and_or_b32 v235, v235, v25, s99
    buffer_store_dwordx4 v[232:235], v31, s[12:15], s62 offen sc1
    s_add_u32 s62, s62, 64
    v_mov_b32 v25, 0xfffff000
    v_add_u32 v236, 0x800, v236
    v_add_u32 v237, 0x800, v237
    v_add_u32 v238, 0x800, v238
    v_add_u32 v239, 0x800, v239
    v_and_or_b32 v236, v236, v25, s96
    v_and_or_b32 v237, v237, v25, s97
    v_and_or_b32 v238, v238, v25, s98
    v_and_or_b32 v239, v239, v25, s99
    buffer_store_dwordx4 v[236:239], v31, s[12:15], s62 offen sc1
    s_add_u32 s62, s62, 64
    v_mov_b32 v25, 0xfffff000
    v_add_u32 v240, 0x800, v240
    v_add_u32 v241, 0x800, v241
    v_add_u32 v242, 0x800, v242
    v_add_u32 v243, 0x800, v243
    v_and_or_b32 v240, v240, v25, s96
    v_and_or_b32 v241, v241, v25, s97
    v_and_or_b32 v242, v242, v25, s98
    v_and_or_b32 v243, v243, v25, s99
    buffer_store_dwordx4 v[240:243], v31, s[12:15], s62 offen sc1
    s_add_u32 s62, s62, 64
    v_mov_b32 v25, 0xfffff000
    v_add_u32 v244, 0x800, v244
    v_add_u32 v245, 0x800, v245
    v_add_u32 v246, 0x800, v246
    v_add_u32 v247, 0x800, v247
    v_and_or_b32 v244, v244, v25, s96
    v_and_or_b32 v245, v245, v25, s97
    v_and_or_b32 v246, v246, v25, s98
    v_and_or_b32 v247, v247, v25, s99
    buffer_store_dwordx4 v[244:247], v31, s[12:15], s62 offen sc1
    s_waitcnt vmcnt(10)
    s_branch L_nm2f
L_nm2d:
    s_waitcnt vmcnt(6)
L_nm2f:
    s_lshl_b32 s62, s54, 2
    v_add_u32 v28, s62, v22
    v_xor_b32 v28, v28, v23
    v_and_b32 v28, 15, v28
    v_lshlrev_b32_e64 v28, 4, v28
    v_lshl_add_u32 v28, v22, 10, v28
    s_lshl_b32 s10, s61, 15
    s_lshl_b32 s63, s54, 12
    s_add_u32 s10, s10, s63
    s_lshl_b32 s11, s58, 8
    s_add_u32 s10, s10, s11
    v_lshlrev_b32 v29, 2, v1
    ds_read_b64_tr_b16 v[192:193], v13 offset:0
    ds_read_b64_tr_b16 v[194:195], v13 offset:1024
    ds_read_b64_tr_b16 v[196:197], v13 offset:2048
    ds_read_b64_tr_b16 v[198:199], v13 offset:3072
    ds_read_b64_tr_b16 v[200:201], v13 offset:4096
    ds_read_b64_tr_b16 v[202:203], v13 offset:5120
    ds_read_b64_tr_b16 v[204:205], v13 offset:6144
    ds_read_b64_tr_b16 v[206:207], v13 offset:7168
    ds_read_b64_tr_b16 v[208:209], v13 offset:8192
    ds_read_b64_tr_b16 v[210:211], v13 offset:9216
    ds_read_b64_tr_b16 v[212:213], v13 offset:10240
    ds_read_b64_tr_b16 v[214:215], v13 offset:11264
    ds_read_b64_tr_b16 v[216:217], v13 offset:12288
    ds_read_b64_tr_b16 v[218:219], v13 offset:13312
    ds_read_b64_tr_b16 v[220:221], v13 offset:14336
    ds_read_b64_tr_b16 v[222:223], v13 offset:15360
    s_waitcnt lgkmcnt(0)
    s_barrier
    s_cmp_eq_u32 s57, 0
    s_cbranch_scc1 L_np
    s_setprio 1
L_np:
    ds_read_b128 v[152:155], v8 offset:7168
    ds_read_b128 v[148:151], v8 offset:6144
    s_mov_b64 exec, s[48:49]
    ds_read_b128 v[132:135], v9 offset:14336
    ds_read_b128 v[136:139], v9 offset:15360
    s_mov_b64 exec, -1
    s_waitcnt lgkmcnt(3)
    v_mfma_f32_32x32x16_bf16 v[84:99], v[152:155], v[32:35], 0
    s_cmp_lt_u32 s52, 1
    s_cbranch_scc1 L_t_2
    s_nop 9
    v_exp_f32 v84, v84
    v_exp_f32 v85, v85
    v_exp_f32 v86, v86
    v_exp_f32 v87, v87
    v_exp_f32_e64 v88, v88
    s_lshl_b32 s69, s54, 10
    s_add_u32 m0, s69, 147456
    s_nop 0
    buffer_load_dwordx4 v28, s[4:7], s10 offen lds
    s_cmp_lg_u32 s54, 7
    s_cbranch_scc1 L_wr_4
    s_mov_b32 m0, 155648
    s_nop 0
    buffer_load_dword v29, s[28:31], s11 offen lds
L_wr_4:
    v_exp_f32 v89, v89
    v_exp_f32 v90, v90
    v_exp_f32 v91, v91
    s_waitcnt lgkmcnt(2)
    v_mfma_f32_32x32x16_bf16 v[68:83], v[148:151], v[32:35], 0
    s_mov_b64 exec, s[48:49]
    ds_read_b128 v[124:127], v9 offset:12288
    ds_read_b128 v[128:131], v9 offset:13312
    s_mov_b64 exec, -1
    v_cvt_pk_bf16_f32 v116, v84, v85
    v_cvt_pk_bf16_f32 v117, v86, v87
    v_cvt_pk_bf16_f32 v118, v88, v89
    v_cvt_pk_bf16_f32 v119, v90, v91
    v_exp_f32 v92, v92
    v_exp_f32 v93, v93
    v_exp_f32 v94, v94
    v_exp_f32_e64 v95, v95
    s_waitcnt lgkmcnt(3)
    v_mfma_f32_32x32x16_bf16 v[100:115], v[132:135], v[116:119], v[100:115]
    v_exp_f32 v96, v96
    v_exp_f32 v97, v97
    v_exp_f32 v98, v98
    v_exp_f32 v99, v99
    s_waitcnt vmcnt(0) lgkmcnt(0)
    s_barrier
    ds_read_b128 v[144:147], v8 offset:5120
    ds_read_b128 v[140:143], v8 offset:4096
    ds_read_b128 v[152:155], v8 offset:3072
    s_cmp_lg_u32 s54, 0
    s_cbranch_scc1 L_ft_5
    buffer_load_dword v20, v30, s[32:35], s8 offen
    buffer_load_dword v21, v30, s[36:39], s8 offen
    buffer_load_dword v15, v31, s[40:43], s9 offen
L_ft_5:
    v_cvt_pk_bf16_f32 v120, v92, v93
    v_cvt_pk_bf16_f32 v121, v94, v95
    v_cvt_pk_bf16_f32 v122, v96, v97
    v_cvt_pk_bf16_f32 v123, v98, v99
    v_exp_f32 v68, v68
    v_exp_f32 v69, v69
    v_mfma_f32_32x32x16_bf16 v[100:115], v[136:139], v[120:123], v[100:115]
    v_exp_f32 v70, v70
    v_exp_f32 v71, v71
    v_exp_f32_e64 v72, v72
    ds_read2st64_b32 v[224:225], v18 offset0:0 offset1:8
    ds_read2st64_b32 v[226:227], v7 offset0:0 offset1:16
    ds_read2st64_b32 v[228:229], v18 offset0:16 offset1:24
    ds_read2st64_b32 v[230:231], v7 offset0:32 offset1:48
    v_exp_f32 v73, v73
    v_exp_f32 v74, v74
    v_exp_f32 v75, v75
    s_waitcnt lgkmcnt(6)
    v_mfma_f32_32x32x16_bf16 v[84:99], v[144:147], v[32:35], 0
    s_mov_b64 exec, s[48:49]
    ds_read_b128 v[132:135], v9 offset:10240
    ds_read_b128 v[136:139], v9 offset:11264
    s_mov_b64 exec, -1
    v_cvt_pk_bf16_f32 v116, v68, v69
    v_cvt_pk_bf16_f32 v117, v70, v71
    v_cvt_pk_bf16_f32 v118, v72, v73
    v_cvt_pk_bf16_f32 v119, v74, v75
    v_exp_f32 v76, v76
    v_exp_f32 v77, v77
    ds_read_b128 v[148:151], v8 offset:2048
    v_exp_f32 v78, v78
    v_exp_f32 v79, v79
    v_mfma_f32_32x32x16_bf16 v[100:115], v[124:127], v[116:119], v[100:115]
    v_exp_f32 v80, v80
    v_exp_f32 v81, v81
    v_exp_f32 v82, v82
    v_exp_f32_e64 v83, v83
    s_waitcnt lgkmcnt(5)
    v_add3_u32 v24, v224, v225, v226
    s_waitcnt lgkmcnt(4)
    v_add3_u32 v24, v24, v227, v228
    s_waitcnt lgkmcnt(3)
    v_add3_u32 v24, v24, v229, v230
    v_add3_u32 v24, v24, v231, v11
    s_nop 1
    v_add_u32_dpp v24, v24, v24 quad_perm:[1,0,3,2] row_mask:0xf bank_mask:0xf
    v_cvt_pk_bf16_f32 v120, v76, v77
    v_cvt_pk_bf16_f32 v121, v78, v79
    v_cvt_pk_bf16_f32 v122, v80, v81
    v_cvt_pk_bf16_f32 v123, v82, v83
    s_nop 1
    v_mfma_f32_32x32x16_bf16 v[100:115], v[128:131], v[120:123], v[100:115]
L_u_3:
    s_cmp_lt_u32 s52, 2
    s_cbranch_scc1 L_t_6
    s_nop 7
    v_exp_f32 v84, v84
    v_exp_f32 v85, v85
    v_exp_f32 v86, v86
    v_exp_f32 v87, v87
    v_exp_f32 v88, v88
    v_add_u32_dpp v24, v24, v24 quad_perm:[2,3,0,1] row_mask:0xf bank_mask:0xf
    v_exp_f32 v89, v89
    v_exp_f32 v90, v90
    v_exp_f32_e64 v91, v91
    v_mfma_f32_32x32x16_bf16 v[68:83], v[140:143], v[32:35], 0
    s_mov_b64 exec, s[48:49]
    ds_read_b128 v[124:127], v9 offset:8192
    ds_read_b128 v[128:131], v9 offset:9216
    s_mov_b64 exec, -1
    v_cvt_pk_bf16_f32 v116, v84, v85
    v_cvt_pk_bf16_f32 v117, v86, v87
    v_cvt_pk_bf16_f32 v118, v88, v89
    v_cvt_pk_bf16_f32 v119, v90, v91
    v_exp_f32 v92, v92
    v_exp_f32 v93, v93
    v_add_u32_dpp v24, v24, v24 row_half_mirror row_mask:0xf bank_mask:0xf
    v_exp_f32 v94, v94
    v_exp_f32_e64 v95, v95
    s_waitcnt lgkmcnt(2)
    v_mfma_f32_32x32x16_bf16 v[100:115], v[132:135], v[116:119], v[100:115]
    v_exp_f32 v96, v96
    v_exp_f32 v97, v97
    v_exp_f32 v98, v98
    v_exp_f32 v99, v99
    v_add_u32_dpp v24, v24, v24 row_mirror row_mask:0xf bank_mask:0xf
    v_cvt_pk_bf16_f32 v120, v92, v93
    v_cvt_pk_bf16_f32 v121, v94, v95
    v_cvt_pk_bf16_f32 v122, v96, v97
    v_cvt_pk_bf16_f32 v123, v98, v99
    v_exp_f32 v68, v68
    v_exp_f32 v69, v69
    v_mfma_f32_32x32x16_bf16 v[100:115], v[136:139], v[120:123], v[100:115]
    v_exp_f32 v70, v70
    v_exp_f32 v71, v71
    v_exp_f32_e64 v72, v72
    v_mov_b32 v25, 161792
    s_mov_b64 exec, s[18:19]
    ds_add_u32 v25, v24
    s_mov_b64 exec, -1
    v_exp_f32 v73, v73
    v_exp_f32 v74, v74
    v_exp_f32_e64 v75, v75
    v_mfma_f32_32x32x16_bf16 v[84:99], v[152:155], v[32:35], 0
    s_mov_b64 exec, s[48:49]
    ds_read_b128 v[132:135], v9 offset:6144
    ds_read_b128 v[136:139], v9 offset:7168
    s_mov_b64 exec, -1
    v_cvt_pk_bf16_f32 v116, v68, v69
    v_cvt_pk_bf16_f32 v117, v70, v71
    v_cvt_pk_bf16_f32 v118, v72, v73
    v_cvt_pk_bf16_f32 v119, v74, v75
    v_exp_f32 v76, v76
    v_exp_f32 v77, v77
    ds_read_b128 v[144:147], v8 offset:1024
    ds_read_b128 v[140:143], v8 offset:0
    v_exp_f32 v78, v78
    v_exp_f32_e64 v79, v79
    s_waitcnt lgkmcnt(6)
    v_mfma_f32_32x32x16_bf16 v[100:115], v[124:127], v[116:119], v[100:115]
    v_exp_f32 v80, v80
    v_exp_f32 v81, v81
    v_exp_f32 v82, v82
    v_exp_f32 v83, v83
    v_cvt_pk_bf16_f32 v120, v76, v77
    v_cvt_pk_bf16_f32 v121, v78, v79
    v_cvt_pk_bf16_f32 v122, v80, v81
    v_cvt_pk_bf16_f32 v123, v82, v83
    s_waitcnt lgkmcnt(5)
    s_nop 0
    v_mfma_f32_32x32x16_bf16 v[100:115], v[128:131], v[120:123], v[100:115]
L_u_7:
    s_cmp_lt_u32 s52, 3
    s_cbranch_scc1 L_t_8
    s_nop 5
    v_exp_f32 v84, v84
    v_exp_f32 v85, v85
    v_exp_f32 v86, v86
    v_exp_f32 v87, v87
    v_exp_f32_e64 v88, v88
    s_add_u32 m0, s23, 0
    s_add_u32 s69, s22, 131072
    buffer_load_dwordx4 v16, s[24:27], s69 offen lds
    s_add_u32 m0, s23, 1024
    s_add_u32 s69, s22, 139264
    buffer_load_dwordx4 v16, s[24:27], s69 offen lds
    v_exp_f32 v89, v89
    v_exp_f32 v90, v90
    v_exp_f32 v91, v91
    s_waitcnt lgkmcnt(0)
    v_mfma_f32_32x32x16_bf16 v[68:83], v[148:151], v[32:35], 0
    s_mov_b64 exec, s[48:49]
    ds_read_b128 v[124:127], v9 offset:4096
    ds_read_b128 v[128:131], v9 offset:5120
    s_mov_b64 exec, -1
    v_cvt_pk_bf16_f32 v116, v84, v85
    v_cvt_pk_bf16_f32 v117, v86, v87
    v_cvt_pk_bf16_f32 v118, v88, v89
    v_cvt_pk_bf16_f32 v119, v90, v91
    v_exp_f32 v92, v92
    v_exp_f32 v93, v93
    s_add_u32 m0, s23, 2048
    s_add_u32 s69, s22, 147456
    buffer_load_dwordx4 v16, s[24:27], s69 offen lds
    v_exp_f32 v94, v94
    v_exp_f32 v95, v95
    v_mfma_f32_32x32x16_bf16 v[100:115], v[132:135], v[116:119], v[100:115]
    v_exp_f32 v96, v96
    v_exp_f32 v97, v97
    v_exp_f32 v98, v98
    v_exp_f32 v99, v99
    s_add_u32 m0, s23, 3072
    s_add_u32 s69, s22, 155648
    buffer_load_dwordx4 v16, s[24:27], s69 offen lds
    v_cvt_pk_bf16_f32 v120, v92, v93
    v_cvt_pk_bf16_f32 v121, v94, v95
    v_cvt_pk_bf16_f32 v122, v96, v97
    v_cvt_pk_bf16_f32 v123, v98, v99
    v_exp_f32 v68, v68
    v_exp_f32 v69, v69
    v_mfma_f32_32x32x16_bf16 v[100:115], v[136:139], v[120:123], v[100:115]
    v_exp_f32 v70, v70
    v_exp_f32 v71, v71
    v_exp_f32_e64 v72, v72
    s_add_u32 m0, s23, 4096
    s_add_u32 s69, s22, 163840
    buffer_load_dwordx4 v16, s[24:27], s69 offen lds
    s_add_u32 m0, s23, 5120
    s_add_u32 s69, s22, 172032
    buffer_load_dwordx4 v16, s[24:27], s69 offen lds
    v_exp_f32 v73, v73
    v_exp_f32 v74, v74
    v_exp_f32_e64 v75, v75
    v_mfma_f32_32x32x16_bf16 v[84:99], v[144:147], v[32:35], v[176:191]
    s_mov_b64 exec, s[48:49]
    ds_read_b128 v[132:135], v9 offset:2048
    ds_read_b128 v[136:139], v9 offset:3072
    s_mov_b64 exec, -1
    v_cvt_pk_bf16_f32 v116, v68, v69
    v_cvt_pk_bf16_f32 v117, v70, v71
    v_cvt_pk_bf16_f32 v118, v72, v73
    v_cvt_pk_bf16_f32 v119, v74, v75
    v_exp_f32 v76, v76
    v_exp_f32 v77, v77
    s_add_u32 m0, s23, 6144
    s_add_u32 s69, s22, 180224
    buffer_load_dwordx4 v16, s[24:27], s69 offen lds
    v_exp_f32 v78, v78
    v_exp_f32_e64 v79, v79
    s_waitcnt lgkmcnt(3)
    v_mfma_f32_32x32x16_bf16 v[100:115], v[124:127], v[116:119], v[100:115]
    v_exp_f32 v80, v80
    v_exp_f32 v81, v81
    v_exp_f32 v82, v82
    v_exp_f32 v83, v83
    s_add_u32 m0, s23, 7168
    s_add_u32 s69, s22, 188416
    buffer_load_dwordx4 v16, s[24:27], s69 offen lds
    v_cvt_pk_bf16_f32 v120, v76, v77
    v_cvt_pk_bf16_f32 v121, v78, v79
    v_cvt_pk_bf16_f32 v122, v80, v81
    v_cvt_pk_bf16_f32 v123, v82, v83
    s_waitcnt lgkmcnt(2)
    s_nop 0
    v_mfma_f32_32x32x16_bf16 v[100:115], v[128:131], v[120:123], v[100:115]
L_u_9:
    s_setprio 0
    s_cmp_lt_u32 s52, 4
    s_cbranch_scc1 L_t_10
    s_nop 2
    v_exp_f32 v84, v84
    v_exp_f32 v85, v85
    v_exp_f32 v86, v86
    v_exp_f32 v87, v87
    v_exp_f32 v88, v88
    v_exp_f32 v89, v89
    v_exp_f32 v90, v90
    v_exp_f32_e64 v91, v91
    s_waitcnt lgkmcnt(0)
    v_mfma_f32_32x32x16_bf16 v[68:83], v[140:143], v[32:35], v[36:51]
    s_mov_b64 exec, s[48:49]
    ds_read_b128 v[124:127], v9 offset:0
    ds_read_b128 v[128:131], v9 offset:1024
    s_mov_b64 exec, -1
    v_cvt_pk_bf16_f32 v116, v84, v85
    v_cvt_pk_bf16_f32 v117, v86, v87
    v_cvt_pk_bf16_f32 v118, v88, v89
    v_cvt_pk_bf16_f32 v119, v90, v91
    v_exp_f32 v92, v92
    v_exp_f32 v93, v93
    v_exp_f32 v94, v94
    v_exp_f32 v95, v95
    v_mfma_f32_32x32x16_bf16 v[100:115], v[132:135], v[116:119], v[100:115]
    v_exp_f32 v96, v96
    v_exp_f32 v97, v97
    v_exp_f32 v98, v98
    v_exp_f32 v99, v99
    v_cvt_pk_bf16_f32 v120, v92, v93
    v_cvt_pk_bf16_f32 v121, v94, v95
    v_cvt_pk_bf16_f32 v122, v96, v97
    v_cvt_pk_bf16_f32 v123, v98, v99
    s_nop 1
    v_mfma_f32_32x32x16_bf16 v[100:115], v[136:139], v[120:123], v[100:115]
    s_cmp_lg_u32 s55, 0
    s_cbranch_scc1 L_t_10
    v_exp_f32 v68, v68
    v_exp_f32 v69, v69
    v_exp_f32 v70, v70
    v_exp_f32 v71, v71
    v_exp_f32 v72, v72
    v_exp_f32 v73, v73
    v_exp_f32 v74, v74
    v_exp_f32_e64 v75, v75
    v_cvt_pk_bf16_f32 v116, v68, v69
    v_cvt_pk_bf16_f32 v117, v70, v71
    v_cvt_pk_bf16_f32 v118, v72, v73
    v_cvt_pk_bf16_f32 v119, v74, v75
    v_exp_f32 v76, v76
    v_exp_f32 v77, v77
    v_exp_f32 v78, v78
    v_exp_f32_e64 v79, v79
    s_waitcnt lgkmcnt(1)
    v_mfma_f32_32x32x16_bf16 v[100:115], v[124:127], v[116:119], v[100:115]
    v_exp_f32 v80, v80
    v_exp_f32 v81, v81
    v_exp_f32 v82, v82
    v_exp_f32 v83, v83
    v_cvt_pk_bf16_f32 v120, v76, v77
    v_cvt_pk_bf16_f32 v121, v78, v79
    v_cvt_pk_bf16_f32 v122, v80, v81
    v_cvt_pk_bf16_f32 v123, v82, v83
    s_waitcnt lgkmcnt(0)
    s_nop 0
    v_mfma_f32_32x32x16_bf16 v[100:115], v[128:131], v[120:123], v[100:115]
L_t_10:
    s_waitcnt vmcnt(0)
    v_mov_b32 v24, 0x21800000
    v_mov_b32 v25, 0x5d800000
    s_nop 9
    v_cmp_nge_f32_e64 vcc, v108, v24
    v_cmp_nle_f32 s[62:63], v108, v25
    s_nop 0
    s_or_b64 vcc, vcc, s[62:63]
    s_cmp_lg_u64 vcc, 0
    s_cbranch_scc1 L_slow
L_attdone:
    s_cmp_lg_u32 s55, 1
    s_cbranch_scc1 L_r_12
    s_add_u32 s62, s67, 0
    buffer_load_dwordx4 v[156:159], v6, s[12:15], s62 offen sc1
    s_add_u32 s62, s67, 16384
    buffer_load_dwordx4 v[160:163], v6, s[12:15], s62 offen sc1
    s_add_u32 s62, s67, 32768
    buffer_load_dwordx4 v[164:167], v6, s[12:15], s62 offen sc1
    s_add_u32 s62, s67, 49152
    buffer_load_dwordx4 v[168:171], v6, s[12:15], s62 offen sc1
L_r_12:
    v_rcp_f32_e64 v24, v108
    s_lshl_b32 s69, s52, 1
    s_add_u32 s69, s69, s55
    s_lshl_b32 s69, s69, 5
    s_lshl_b32 s63, s53, 2
    s_add_u32 s69, s69, s63
    s_lshl_b32 s63, s56, 1
    s_add_u32 s69, s69, s63
    s_add_u32 s69, s69, s57
    s_lshl_b32 s62, s69, 10
    s_add_u32 s62, s62, 0x700000
    v_mul_f32 v100, v100, v24
    v_mul_f32 v101, v101, v24
    v_mul_f32 v102, v102, v24
    v_mul_f32 v103, v103, v24
    v_mul_f32 v104, v104, v24
    v_mul_f32 v105, v105, v24
    v_mul_f32 v106, v106, v24
    v_mul_f32 v107, v107, v24
    v_cvt_pk_bf16_f32 v116, v100, v101
    v_cvt_pk_bf16_f32 v117, v102, v103
    v_cvt_pk_bf16_f32 v118, v104, v105
    v_cvt_pk_bf16_f32 v119, v106, v107
    buffer_store_dwordx4 v[116:119], v2, s[12:15], s62 offen sc1
    v_mov_b32 v25, v116
    s_lshl_b32 s62, s55, 2
    s_add_u32 s62, s62, 161800
    v_mov_b32_e64 v27, s62
    v_add_u32_dpp v25, v25, v25 quad_perm:[1,0,3,2] row_mask:0xf bank_mask:0xf
    s_nop 1
    v_add_u32_dpp v25, v25, v25 quad_perm:[2,3,0,1] row_mask:0xf bank_mask:0xf
    s_nop 1
    v_add_u32_dpp v25, v25, v25 row_half_mirror row_mask:0xf bank_mask:0xf
    s_nop 1
    v_add_u32_dpp v25, v25, v25 row_mirror row_mask:0xf bank_mask:0xf
    s_mov_b64 exec, s[18:19]
    ds_add_u32 v27, v25
    s_mov_b64 exec, -1
    v_mov_b32 v28, 161792
    s_waitcnt lgkmcnt(0)
    s_barrier
    ds_read_b128 v[24:27], v28
    s_lshl_b32 s48, s61, 10
    s_lshl_b32 s62, s54, 7
    s_add_u32 s48, s48, s62
    s_add_u32 s48, s48, 0xf0000
    s_lshl_b32 s69, s52, 4
    s_add_u32 s69, s69, s53
    s_lshl_b32 s69, s69, 7
    s_add_u32 s69, s69, 0xf0000
    v_lshlrev_b32 v29, 10, v3
    v_lshl_add_u32 v29, v23, 3, v29
    v_cmp_eq_u32 vcc, 0, v3
    s_waitcnt lgkmcnt(0)
    v_readfirstlane_b32 s62, v24
    s_nop 0
    s_cmp_lg_u32 s62, 0
    s_cbranch_scc1 L_kvredo
    s_cmp_lg_u32 s54, 0
    s_cbranch_scc1 L_noann
    v_cndmask_b32 v25, v27, v26, vcc
    v_mov_b32 v24, s59
    buffer_store_dwordx2 v[24:25], v29, s[12:15], s69 offen sc1
L_noann:
    ds_read_b64_tr_b16 v[224:225], v13 offset:0
    ds_read_b64_tr_b16 v[226:227], v13 offset:1024
    ds_read_b64_tr_b16 v[228:229], v13 offset:2048
    ds_read_b64_tr_b16 v[230:231], v13 offset:3072
    ds_read_b64_tr_b16 v[232:233], v13 offset:4096
    ds_read_b64_tr_b16 v[234:235], v13 offset:5120
    ds_read_b64_tr_b16 v[236:237], v13 offset:6144
    ds_read_b64_tr_b16 v[238:239], v13 offset:7168
    ds_read_b64_tr_b16 v[240:241], v13 offset:8192
    ds_read_b64_tr_b16 v[242:243], v13 offset:9216
    ds_read_b64_tr_b16 v[244:245], v13 offset:10240
    ds_read_b64_tr_b16 v[246:247], v13 offset:11264
    ds_read_b64_tr_b16 v[248:249], v13 offset:12288
    ds_read_b64_tr_b16 v[250:251], v13 offset:13312
    ds_read_b64_tr_b16 v[252:253], v13 offset:14336
    ds_read_b64_tr_b16 v[254:255], v13 offset:15360
    s_cmp_eq_u32 s55, 0
    s_cbranch_scc1 L_nom2c
    s_mov_b32 s68, 0
    s_waitcnt vmcnt(1)
    s_branch L_m2chk
L_m2poll:
    s_add_u32 s62, s67, 0
    buffer_load_dwordx4 v[156:159], v6, s[12:15], s62 offen sc1
    s_add_u32 s62, s67, 16384
    buffer_load_dwordx4 v[160:163], v6, s[12:15], s62 offen sc1
    s_add_u32 s62, s67, 32768
    buffer_load_dwordx4 v[164:167], v6, s[12:15], s62 offen sc1
    s_add_u32 s62, s67, 49152
    buffer_load_dwordx4 v[168:171], v6, s[12:15], s62 offen sc1
    s_waitcnt vmcnt(0)
L_m2chk:
    v_xor_b32 v156, s96, v156
    v_xor_b32 v157, s97, v157
    v_xor_b32 v158, s98, v158
    v_xor_b32 v159, s99, v159
    v_xor_b32 v160, s96, v160
    v_xor_b32 v161, s97, v161
    v_xor_b32 v162, s98, v162
    v_xor_b32 v163, s99, v163
    v_xor_b32 v164, s96, v164
    v_xor_b32 v165, s97, v165
    v_xor_b32 v166, s98, v166
    v_xor_b32 v167, s99, v167
    v_xor_b32 v168, s96, v168
    v_xor_b32 v169, s97, v169
    v_xor_b32 v170, s98, v170
    v_xor_b32 v171, s99, v171
    v_or_b32 v26, v156, v157
    v_or3_b32 v26, v26, v158, v159
    v_or3_b32 v26, v26, v160, v161
    v_or3_b32 v26, v26, v162, v163
    v_or3_b32 v26, v26, v164, v165
    v_or3_b32 v26, v26, v166, v167
    v_or3_b32 v26, v26, v168, v169
    v_or3_b32 v26, v26, v170, v171
    v_and_b32 v26, 0xfff, v26
    v_cmp_ne_u32_e64 vcc, 0, v26
    s_nop 0
    s_cmp_eq_u64 vcc, 0
    s_cbranch_scc1 L_m2done
    s_add_u32 s68, s68, 1
    s_cmp_lt_u32 s68, 400000
    s_sleep 4
    s_cbranch_scc1 L_m2poll
L_m2done:
    v_pk_add_f32 v[156:157], v[156:157], v[160:161]
    v_pk_add_f32 v[158:159], v[158:159], v[162:163]
    v_pk_add_f32 v[164:165], v[164:165], v[168:169]
    v_pk_add_f32 v[166:167], v[166:167], v[170:171]
    v_pk_add_f32 v[160:161], v[156:157], v[164:165]
    v_pk_add_f32 v[162:163], v[158:159], v[166:167]
    v_pk_add_f32 v[156:157], v[156:157], v[164:165]
    v_pk_add_f32 v[158:159], v[158:159], v[166:167]
    s_cmp_eq_u32 s21, 2
    s_cselect_b32 s63, 1.0, 0
    v_permlane32_swap_b32 v160, v156
    v_permlane32_swap_b32 v161, v157
    v_permlane32_swap_b32 v162, v158
    v_permlane32_swap_b32 v163, v159
    v_pk_add_f32 v[156:157], v[160:161], v[156:157]
    v_pk_add_f32 v[158:159], v[162:163], v[158:159]
    v_cvt_pk_bf16_f32 v160, v156, v157
    v_cvt_pk_bf16_f32 v161, v158, v159
    v_lshlrev_b32_e64 v156, 16, v160
    v_and_b32 v157, 0xffff0000, v160
    v_lshlrev_b32_e64 v158, 16, v161
    v_and_b32 v159, 0xffff0000, v161
    v_add_f32 v156, s63, v156
    v_add_f32 v157, s63, v157
    v_add_f32 v158, s63, v158
    v_add_f32 v159, s63, v159
    v_cvt_pk_bf16_f32 v160, v156, v157
    v_cvt_pk_bf16_f32 v161, v158, v159
    v_lshlrev_b32_e64 v156, 16, v160
    v_and_b32 v157, 0xffff0000, v160
    v_lshlrev_b32_e64 v158, 16, v161
    v_and_b32 v159, 0xffff0000, v161
    s_lshl_b32 s62, s21, 9
    s_add_u32 s62, s62, 159744
    v_lshl_add_u32 v26, v4, 4, s62
    ds_write_b128 v26, v[156:159]
L_nom2c:
    v_mov_b32 v27, 0
    buffer_load_dwordx2 v[28:29], v27, s[12:15], s48 offen sc1
    s_lshl_b32 s62, s66, 2
    s_add_u32 s62, s62, 159744
    v_lshl_add_u32 v8, v3, 4, s62
    s_lshr_b32 s62, s66, 3
    v_xor_b32 v9, s62, v23
    v_lshlrev_b32 v9, 4, v9
    v_lshl_add_u32 v9, v4, 8, v9
    v_lshlrev_b32 v11, 4, v3
    v_xor_b32 v11, v11, v9
    v_add_u32 v11, 65536, v11
    v_lshl_add_u32 v9, v3, 3, v9
    v_add_u32 v9, 147456, v9
    v_xor_b32 v10, 16, v9
    s_lshl_b32 s62, s66, 1
    s_add_u32 s62, s62, 155648
    v_lshl_add_u32 v13, v3, 3, s62
    s_lshl_b32 s50, s54, 12
    s_lshl_b32 s64, s61, 15
    s_add_u32 s64, s64, s50
    s_lshl_b32 s62, s58, 8
    s_add_u32 s1, s64, s62
    s_add_u32 s64, s64, 0x700000
    s_add_u32 s50, s50, 49152
    v_add_u32_e64 v6, s50, v2
    s_lshl_b32 s62, s57, 14
    s_add_u32 s62, s62, 49152
    v_add_u32 v7, s62, v2
    s_lshl_b32 s62, s54, 12
    v_add_u32_e64 v19, s62, v2
    v_xor_b32 v18, 16384, v19
    s_waitcnt lgkmcnt(0)
    s_barrier
    ds_read2_b64 v[100:103], v13 offset0:0 offset1:2
    ds_read_b128 v[44:47], v8 offset:512
    ds_read_b128 v[48:51], v8 offset:544
    ds_read_b128 v[52:55], v8 offset:1024
    ds_read_b128 v[56:59], v8 offset:1056
    ds_read_b128 v[36:39], v8 offset:0
    ds_read_b128 v[40:43], v8 offset:32
    ds_read_b128 v[60:63], v8 offset:1536
    ds_read_b128 v[64:67], v8 offset:1568
    ds_read_b64 v[96:97], v9
    ds_read_b64 v[98:99], v10
    s_waitcnt lgkmcnt(10)
    v_lshlrev_b32 v76, 16, v100
    v_and_b32 v77, 0xffff0000, v100
    v_lshlrev_b32_e64 v78, 16, v101
    v_and_b32 v79, 0xffff0000, v101
    v_lshlrev_b32_e64 v80, 16, v102
    v_and_b32 v81, 0xffff0000, v102
    v_lshlrev_b32_e64 v82, 16, v103
    v_and_b32 v83, 0xffff0000, v103
    s_waitcnt lgkmcnt(9)
    v_mul_f32 v33, v44, v76
    v_fmac_f32 v33, v45, v77
    v_fmac_f32 v33, v46, v78
    v_fmac_f32 v33, v47, v79
    s_waitcnt lgkmcnt(8)
    v_fmac_f32 v33, v48, v80
    v_fmac_f32 v33, v49, v81
    v_fmac_f32 v33, v50, v82
    v_fmac_f32 v33, v51, v83
    s_waitcnt lgkmcnt(7)
    v_mul_f32 v76, v76, v52
    v_mul_f32 v77, v77, v53
    v_mul_f32 v78, v78, v54
    v_mul_f32 v79, v79, v55
    s_waitcnt lgkmcnt(6)
    v_mul_f32 v80, v80, v56
    v_mul_f32 v81, v81, v57
    v_mul_f32 v82, v82, v58
    v_mul_f32 v83, v83, v59
    v_add_f32 v32, v76, v77
    v_add_f32 v32, v32, v78
    v_add_f32 v32, v32, v79
    v_add_f32 v32, v32, v80
    v_add_f32 v32, v32, v81
    v_add_f32 v32, v32, v82
    v_add_f32_e64 v32, v32, v83
    s_mov_b32 s62, 0xaaaaaaaa
    s_mov_b32 s63, 0xaaaaaaaa
    v_cndmask_b32_e64 v35, v32, v33, s[62:63]
    s_mov_b32 s68, 0
    s_branch L_ofchk
L_ofpoll:
    s_waitcnt vmcnt(0)
    buffer_load_dwordx2 v[28:29], v27, s[12:15], s48 offen sc1
L_ofchk:
    s_waitcnt vmcnt(0)
    v_cmp_ne_u32_e64 vcc, s59, v28
    s_nop 0
    s_cmp_eq_u64 vcc, 0
    s_cbranch_scc1 L_ofok
    s_add_u32 s68, s68, 1
    s_cmp_lt_u32 s68, 400000
    s_sleep 2
    s_cbranch_scc1 L_ofpoll
L_ofok:
    s_mov_b32 m0, s50
    s_nop 0
    buffer_load_dwordx4 v2, s[12:15], s64 offen offset:0 sc1 lds
    buffer_load_dwordx4 v2, s[12:15], s64 offen offset:1024 sc1 lds
    buffer_load_dwordx4 v2, s[12:15], s64 offen offset:2048 sc1 lds
    buffer_load_dwordx4 v2, s[12:15], s64 offen offset:3072 sc1 lds
    s_mov_b32 s68, 0
L_proj:
    s_waitcnt lgkmcnt(1)
    v_lshlrev_b32_e64 v68, 16, v96
    v_and_b32 v69, 0xffff0000, v96
    v_lshlrev_b32_e64 v70, 16, v97
    v_and_b32 v71, 0xffff0000, v97
    s_waitcnt lgkmcnt(0)
    v_lshlrev_b32 v72, 16, v98
    v_and_b32 v73, 0xffff0000, v98
    v_lshlrev_b32_e64 v74, 16, v99
    v_and_b32 v75, 0xffff0000, v99
    s_waitcnt vmcnt(0) lgkmcnt(0)
    s_barrier
    ds_read_b128 v[112:115], v7 offset:0
    ds_read_b128 v[116:119], v7 offset:1024
    ds_read_b128 v[120:123], v7 offset:2048
    ds_read_b128 v[124:127], v7 offset:3072
    s_waitcnt lgkmcnt(3)
    v_mfma_f32_32x32x16_bf16 v[176:191], v[192:195], v[112:115], 0
    ds_read_b128 v[128:131], v7 offset:4096
    s_cmp_ge_u32 s3, 14
    s_cbranch_scc1 L_fd_13
    s_xor_b32 m0, s60, 0
    s_nop 0
    buffer_load_dwordx4 v17, s[32:35], s65 offen lds
    s_add_u32 m0, s95, 81920
    s_nop 0
    buffer_load_dwordx4 v2, s[40:43], s0 offen offset:0 lds
L_fd_13:
    s_waitcnt lgkmcnt(3)
    v_mfma_f32_32x32x16_bf16 v[176:191], v[196:199], v[116:119], v[176:191]
    ds_read_b128 v[132:135], v7 offset:5120
    ds_read2st64_b32 v[104:105], v6 offset0:0 offset1:4
    ds_read2st64_b32 v[106:107], v6 offset0:8 offset1:12
    s_waitcnt lgkmcnt(5)
    v_mfma_f32_32x32x16_bf16 v[176:191], v[200:203], v[120:123], v[176:191]
    ds_read_b128 v[136:139], v7 offset:6144
    s_waitcnt lgkmcnt(5)
    v_mfma_f32_32x32x16_bf16 v[176:191], v[204:207], v[124:127], v[176:191]
    ds_read_b128 v[140:143], v7 offset:7168
    s_cmp_ge_u32 s3, 14
    s_cbranch_scc1 L_fd_14
    s_xor_b32 m0, s60, 1024
    s_nop 0
    buffer_load_dwordx4 v17, s[32:35], s20 offen lds
    s_add_u32 m0, s95, 81920
    s_nop 0
    buffer_load_dwordx4 v2, s[40:43], s0 offen offset:1024 lds
L_fd_14:
    s_waitcnt lgkmcnt(5)
    v_mfma_f32_32x32x16_bf16 v[176:191], v[208:211], v[128:131], v[176:191]
    ds_read_b128 v[144:147], v7 offset:8192
    s_waitcnt lgkmcnt(5)
    v_mfma_f32_32x32x16_bf16 v[176:191], v[212:215], v[132:135], v[176:191]
    ds_read_b128 v[148:151], v7 offset:9216
    s_waitcnt lgkmcnt(5)
    v_add_u32 v30, v104, v105
    s_waitcnt lgkmcnt(4)
    v_add3_u32 v30, v30, v106, v107
    s_waitcnt lgkmcnt(3)
    v_mfma_f32_32x32x16_bf16 v[176:191], v[216:219], v[136:139], v[176:191]
    ds_read_b128 v[152:155], v7 offset:10240
    v_add_u32_dpp v30, v30, v30 quad_perm:[1,0,3,2] row_mask:0xf bank_mask:0xf
    s_waitcnt lgkmcnt(3)
    v_mfma_f32_32x32x16_bf16 v[176:191], v[220:223], v[140:143], v[176:191]
    ds_read_b128 v[156:159], v7 offset:11264
    v_add_u32_dpp v30, v30, v30 quad_perm:[2,3,0,1] row_mask:0xf bank_mask:0xf
    s_cmp_ge_u32 s3, 14
    s_cbranch_scc1 L_fd_15
    s_xor_b32 m0, s60, 16384
    s_nop 0
    buffer_load_dwordx4 v17, s[36:39], s65 offen lds
L_fd_15:
    s_waitcnt lgkmcnt(3)
    v_mfma_f32_32x32x16_bf16 v[176:191], v[224:227], v[144:147], v[176:191]
    ds_read_b128 v[160:163], v7 offset:12288
    v_add_u32_dpp v30, v30, v30 row_half_mirror row_mask:0xf bank_mask:0xf
    s_waitcnt lgkmcnt(3)
    v_mfma_f32_32x32x16_bf16 v[176:191], v[228:231], v[148:151], v[176:191]
    ds_read_b128 v[164:167], v7 offset:13312
    v_add_u32_dpp v30, v30, v30 row_mirror row_mask:0xf bank_mask:0xf
    s_waitcnt lgkmcnt(3)
    v_mfma_f32_32x32x16_bf16 v[176:191], v[232:235], v[152:155], v[176:191]
    ds_read_b128 v[168:171], v7 offset:14336
    v_mov_b32 v31, v30
    s_nop 1
    v_permlane16_swap_b32 v31, v30
    v_add_u32_e64 v30, v30, v31
    s_waitcnt lgkmcnt(3)
    v_mfma_f32_32x32x16_bf16 v[176:191], v[236:239], v[156:159], v[176:191]
    ds_read_b128 v[172:175], v7 offset:15360
    v_mov_b32 v31, v30
    s_nop 1
    v_permlane32_swap_b32 v31, v30
    v_add_u32 v30, v30, v31
    s_cmp_ge_u32 s3, 14
    s_cbranch_scc1 L_fd_16
    s_xor_b32 m0, s60, 17408
    s_nop 0
    buffer_load_dwordx4 v17, s[36:39], s20 offen lds
L_fd_16:
    s_waitcnt lgkmcnt(3)
    v_mfma_f32_32x32x16_bf16 v[176:191], v[240:243], v[160:163], v[176:191]
    v_cmp_ne_u32 vcc, v30, v29
    s_nop 0
    s_cmp_eq_u64 vcc, 0
    s_cbranch_scc1 L_ook
    v_mov_b32 v24, 161796
    s_add_u32 s62, s68, 1
    v_mov_b32 v25, s62
    ds_write_b32 v24, v25
L_ook:
    s_waitcnt lgkmcnt(2)
    v_mfma_f32_32x32x16_bf16 v[176:191], v[244:247], v[164:167], v[176:191]
    s_waitcnt lgkmcnt(1)
    v_mfma_f32_32x32x16_bf16 v[176:191], v[248:251], v[168:171], v[176:191]
    s_waitcnt lgkmcnt(0)
    v_mfma_f32_32x32x16_bf16 v[176:191], v[252:255], v[172:175], v[176:191]
    s_cmp_eq_u32 s57, 0
    s_cbranch_scc1 L_khs0
    s_nop 9
    ds_write_b128 v19, v[176:179]
    ds_write_b128 v19, v[180:183] offset:2048
    v_fma_f32 v68, v184, v36, v68
    v_fma_f32 v69, v185, v37, v69
    v_fma_f32 v70, v186, v38, v70
    v_fma_f32 v71, v187, v39, v71
    v_fma_f32 v72, v188, v40, v72
    v_fma_f32 v73, v189, v41, v73
    v_fma_f32 v74, v190, v42, v74
    v_fma_f32 v75, v191, v43, v75
    s_branch L_khsj
L_khs0:
    s_nop 9
    ds_write_b128 v19, v[184:187]
    ds_write_b128 v19, v[188:191] offset:2048
    v_fma_f32 v68, v176, v36, v68
    v_fma_f32 v69, v177, v37, v69
    v_fma_f32 v70, v178, v38, v70
    v_fma_f32 v71, v179, v39, v71
    v_fma_f32 v72, v180, v40, v72
    v_fma_f32 v73, v181, v41, v73
    v_fma_f32 v74, v182, v42, v74
    v_fma_f32 v75, v183, v43, v75
L_khsj:
    v_mov_b32 v24, 161796
    s_lshl_b32 s62, s54, 10
    v_add_u32 v26, s62, v2
    s_waitcnt lgkmcnt(0)
    s_barrier
    ds_read_b32 v25, v24
    s_nop 3
    ds_read_b128 v[176:179], v18
    ds_read_b128 v[180:183], v18 offset:2048
    s_add_u32 s68, s68, 1
    s_waitcnt lgkmcnt(2)
    v_readfirstlane_b32 s62, v25
    s_nop 0
    s_cmp_eq_u32 s62, s68
    s_cbranch_scc1 L_oredo
L_ogo:
    s_waitcnt lgkmcnt(1)
    v_fma_f32 v68, v176, v36, v68
    v_fma_f32 v69, v177, v37, v69
    v_fma_f32 v70, v178, v38, v70
    v_fma_f32 v71, v179, v39, v71
    s_waitcnt lgkmcnt(0)
    v_fma_f32 v72, v180, v40, v72
    v_fma_f32 v73, v181, v41, v73
    v_fma_f32 v74, v182, v42, v74
    v_fma_f32 v75, v183, v43, v75
    v_cvt_pk_bf16_f32 v84, v68, v69
    v_cvt_pk_bf16_f32 v85, v70, v71
    v_cvt_pk_bf16_f32 v86, v72, v73
    v_cvt_pk_bf16_f32 v87, v74, v75
    v_lshlrev_b32 v68, 16, v84
    v_and_b32 v69, 0xffff0000, v84
    v_lshlrev_b32_e64 v70, 16, v85
    v_and_b32 v71, 0xffff0000, v85
    v_lshlrev_b32_e64 v72, 16, v86
    v_and_b32 v73, 0xffff0000, v86
    v_lshlrev_b32_e64 v74, 16, v87
    v_and_b32 v75, 0xffff0000, v87
    s_mov_b32 s62, 0x3f803f80
    v_dot2_f32_bf16 v32, v84, s62, 0
    v_dot2_f32_bf16 v33, v84, v84, 0
    v_mul_f32 v34, v68, v76
    v_mul_f32 v30, v69, v77
    v_dot2_f32_bf16 v32, v85, s62, v32
    v_dot2_f32_bf16 v33, v85, v85, v33
    v_fmac_f32 v34, v70, v78
    v_fmac_f32 v30, v71, v79
    v_dot2_f32_bf16 v32, v86, s62, v32
    v_dot2_f32_bf16 v33, v86, v86, v33
    v_fmac_f32 v34, v72, v80
    v_fmac_f32 v30, v73, v81
    v_dot2_f32_bf16 v32, v87, s62, v32
    v_dot2_f32_bf16 v33, v87, v87, v33
    v_fmac_f32 v34, v74, v82
    v_fmac_f32 v30, v75, v83
    v_add_f32_e64 v34, v34, v30
    ds_write_b128 v26, v[32:35] offset:49152
    s_waitcnt lgkmcnt(0)
    s_barrier
    s_cmp_lg_u32 s54, 7
    s_cbranch_scc1 L_stwait
    s_setprio 3
    ds_read_b128 v[112:115], v2 offset:49152
    ds_read_b128 v[116:119], v2 offset:50176
    ds_read_b128 v[120:123], v2 offset:51200
    ds_read_b128 v[124:127], v2 offset:52224
    ds_read_b128 v[128:131], v2 offset:53248
    ds_read_b128 v[132:135], v2 offset:54272
    ds_read_b128 v[136:139], v2 offset:55296
    ds_read_b128 v[140:143], v2 offset:56320
    s_lshl_b32 s64, s61, 12
    s_add_u32 s64, s64, 0x20000
    s_lshl_b32 s62, s58, 10
    s_add_u32 s62, s62, s64
    s_waitcnt lgkmcnt(6)
    v_pk_add_f32 v[112:113], v[112:113], v[116:117]
    v_pk_add_f32 v[114:115], v[114:115], v[118:119]
    s_waitcnt lgkmcnt(4)
    v_pk_add_f32 v[120:121], v[120:121], v[124:125]
    v_pk_add_f32 v[122:123], v[122:123], v[126:127]
    s_waitcnt lgkmcnt(2)
    v_pk_add_f32 v[128:129], v[128:129], v[132:133]
    v_pk_add_f32 v[130:131], v[130:131], v[134:135]
    s_waitcnt lgkmcnt(0)
    v_pk_add_f32 v[136:137], v[136:137], v[140:141]
    v_pk_add_f32 v[138:139], v[138:139], v[142:143]
    v_pk_add_f32 v[112:113], v[112:113], v[120:121]
    v_pk_add_f32 v[114:115], v[114:115], v[122:123]
    v_pk_add_f32 v[128:129], v[128:129], v[136:137]
    v_pk_add_f32 v[130:131], v[130:131], v[138:139]
    v_pk_add_f32 v[116:117], v[112:113], v[128:129]
    v_pk_add_f32 v[118:119], v[114:115], v[130:131]
    v_pk_add_f32 v[112:113], v[112:113], v[128:129]
    v_pk_add_f32 v[114:115], v[114:115], v[130:131]
    v_cmp_eq_u32_e64 vcc, 0, v3
    v_permlane32_swap_b32 v116, v112
    v_permlane32_swap_b32 v117, v113
    v_permlane32_swap_b32 v118, v114
    v_permlane32_swap_b32 v119, v115
    v_pk_add_f32 v[112:113], v[112:113], v[116:117]
    v_pk_add_f32 v[114:115], v[114:115], v[118:119]
    v_cndmask_b32_e64 v112, v115, v112, vcc
    v_add3_u32 v115, v114, v113, s59
    v_add_u32 v115, v115, v112
    s_mov_b32 s69, s62
    v_mov_b64 v[136:137], v[112:113]
    v_mov_b64 v[138:139], v[114:115]
    buffer_store_dwordx4 v[112:115], v2, s[12:15], s69 offen
    s_lshl_b32 s62, s61, 6
    s_sub_u32 s62, 4094, s62
    v_lshlrev_b32 v30, 1, v4
    v_sub_u32 v30, s62, v30
    s_mov_b32 s68, 0
L_stpoll:
    s_cmp_lg_u32 s68, 6
    s_cbranch_scc1 L_stl
    buffer_store_dwordx4 v[136:139], v2, s[12:15], s69 offen sc1
L_stl:
    buffer_load_dwordx4 v[120:123], v2, s[12:15], s64 offen offset:0 sc1
    buffer_load_dwordx4 v[124:127], v2, s[12:15], s64 offen offset:1024 sc1
    buffer_load_dwordx4 v[128:131], v2, s[12:15], s64 offen offset:2048 sc1
    buffer_load_dwordx4 v[132:135], v2, s[12:15], s64 offen offset:3072 sc1
    s_waitcnt vmcnt(3)
    v_add3_u32 v24, v120, v121, s59
    v_sub_u32 v123, v123, v122
    v_xor_b32 v24, v24, v123
    s_waitcnt vmcnt(2)
    v_add3_u32 v25, v124, v125, s59
    v_sub_u32 v127, v127, v126
    v_xor_b32_e64 v25, v25, v127
    s_waitcnt vmcnt(1)
    v_add3_u32 v26, v128, v129, s59
    v_sub_u32 v131, v131, v130
    v_xor_b32_e64 v26, v26, v131
    s_waitcnt vmcnt(0)
    v_add3_u32 v27, v132, v133, s59
    v_sub_u32 v135, v135, v134
    v_xor_b32 v27, v27, v135
    v_or3_b32 v24, v24, v25, v26
    v_or_b32 v24, v24, v27
    v_cmp_ne_u32 vcc, 0, v24
    v_pk_add_f32 v[112:113], v[120:121], v[124:125]
    v_pk_add_f32 v[114:115], v[122:123], v[126:127]
    v_pk_add_f32 v[116:117], v[128:129], v[132:133]
    v_pk_add_f32 v[118:119], v[130:131], v[134:135]
    s_cmp_eq_u64 vcc, 0
    s_cbranch_scc1 L_stdone
    s_add_u32 s68, s68, 1
    s_cmp_lt_u32 s68, 400000
    s_sleep 1
    s_cbranch_scc1 L_stpoll
L_stdone:
    v_pk_add_f32 v[112:113], v[112:113], v[116:117]
    v_pk_add_f32 v[114:115], v[114:115], v[118:119]
    v_readlane_b32 s66, v112, 32
    v_readlane_b32 s67, v112, 33
    s_mov_b32 s62, 0x3b000000
    s_mov_b32 s63, 0x3727c5ac
    v_mul_f32 v112, s62, v112
    v_mul_f32_e64 v113, s62, v113
    v_fma_f32 v113, -v112, v112, v113
    v_max_f32_e64 v113, 0, v113
    v_cvt_pk_bf16_f32 v113, v112, v113
    v_lshlrev_b32_e64 v112, 16, v113
    v_and_b32 v113, 0xffff0000, v113
    v_add_f32_e64 v113, s63, v113
    v_cvt_pk_bf16_f32 v113, v113, v113
    v_and_b32 v113, 0xffff0000, v113
    v_sqrt_f32 v113, v113
    s_nop 0
    v_cvt_pk_bf16_f32 v113, v113, v113
    v_and_b32 v113, 0xffff0000, v113
    v_rcp_f32_e64 v113, v113
    v_fma_f32 v114, -v112, s66, v114
    v_mul_f32 v112, -v112, v113
    v_fma_f32 v114, v114, v113, s67
    s_mov_b32 s62, 0xfffff000
    v_ashrrev_i32_e64 v24, 31, v114
    v_bitop3_b32 v24, v24, v114, s62 bitop3:0x28
    v_ashrrev_i32 v25, 31, v114
    v_not_b32 v25, v25
    v_and_b32 v25, 0x80000000, v25
    v_or3_b32 v114, v24, v25, v30
    v_mov_b32 v24, v114
    s_nop 1
    v_max_u32_dpp v24, v24, v24 quad_perm:[1,0,3,2] row_mask:0xf bank_mask:0xf
    s_nop 1
    v_max_u32_dpp v24, v24, v24 quad_perm:[2,3,0,1] row_mask:0xf bank_mask:0xf
    s_nop 1
    v_max_u32_dpp v24, v24, v24 row_half_mirror row_mask:0xf bank_mask:0xf
    s_nop 1
    v_max_u32_dpp v24, v24, v24 row_mirror row_mask:0xf bank_mask:0xf
    v_mov_b32 v25, v24
    s_nop 1
    v_permlane16_swap_b32 v25, v24
    v_max_u32 v24, v24, v25
    v_cmp_eq_u32_e64 vcc, v24, v114
    s_nop 1
    v_cndmask_b32_e64 v26, v114, 0, vcc
    v_cndmask_b32_e64 v115, 2, 0, vcc
    s_nop 0
    v_max_u32_dpp v26, v26, v26 quad_perm:[1,0,3,2] row_mask:0xf bank_mask:0xf
    s_nop 1
    v_max_u32_dpp v26, v26, v26 quad_perm:[2,3,0,1] row_mask:0xf bank_mask:0xf
    s_nop 1
    v_max_u32_dpp v26, v26, v26 row_half_mirror row_mask:0xf bank_mask:0xf
    s_nop 1
    v_max_u32_dpp v26, v26, v26 row_mirror row_mask:0xf bank_mask:0xf
    v_mov_b32 v25, v26
    s_nop 1
    v_permlane16_swap_b32 v25, v26
    v_max_u32 v26, v26, v25
    v_mov_b32 v28, 0x7ffffff0
    s_cmp_eq_u32 s58, 3
    s_cselect_b32 s63, 32, 0
    v_lshrrev_b32 v29, 2, v1
    v_lshlrev_b32 v29, 12, v29
    v_and_or_b32 v29, v2, 48, v29
    v_cmp_gt_u32 s[66:67], s63, v1
    v_cmp_eq_u32 vcc, v26, v114
    s_lshl_b32 s62, s61, 6
    s_add_u32 s62, s62, 0x8000
    v_cndmask_b32_e64 v28, v28, v29, s[66:67]
    v_cndmask_b32_e64 v114, v115, 1, vcc
    v_or_b32 v26, 1, v26
    v_mov_b32 v25, s59
    v_mov_b32_e64 v27, s59
    ds_write_b128 v2, v[112:115] offset:57344
    buffer_store_dwordx4 v[24:27], v28, s[12:15], s62 offen sc1
    buffer_store_dwordx4 v[136:139], v2, s[12:15], s69 offen sc1
    s_setprio 0
L_stwait:
    v_lshlrev_b32_e64 v24, 4, v4
    v_permlane32_swap_b32 v84, v86
    v_permlane32_swap_b32 v85, v87
    s_lshl_b32 s62, s94, 1
    s_lshl_b32 s63, s61, 12
    s_add_u32 s62, s62, s63
    s_add_u32 s63, s62, 0xa0000
    s_add_u32 s62, s62, 0x60000
    v_add3_u32 v9, v84, v85, s59
    v_add3_u32 v9, v9, v86, v87
    v_lshlrev_b32_e64 v10, 10, v22
    v_lshl_add_u32 v10, v23, 4, v10
    s_lshl_b32 s69, s54, 2
    v_add_u32 v13, s69, v22
    v_xor_b32 v15, v13, v23
    v_and_b32 v15, 15, v15
    v_lshlrev_b32_e64 v15, 4, v15
    v_lshl_add_u32 v15, v13, 8, v15
    v_add_u32 v15, 65536, v15
    v_mov_b32 v25, 0x7ffffff0
    s_cmp_eq_u32 s54, 7
    s_cbranch_scc1 L_st7
    s_waitcnt vmcnt(0)
L_st7:
    s_waitcnt lgkmcnt(0)
    s_barrier
    ds_read_b128 v[28:31], v24 offset:57344
    s_waitcnt lgkmcnt(0)
    v_fma_f32 v176, v68, v29, v28
    v_fma_f32 v177, v69, v29, v28
    v_fma_f32 v178, v70, v29, v28
    v_fma_f32 v179, v71, v29, v28
    v_fma_f32 v180, v72, v29, v28
    v_fma_f32 v181, v73, v29, v28
    v_fma_f32 v182, v74, v29, v28
    v_fma_f32 v183, v75, v29, v28
    v_lshlrev_b32 v8, 11, v30
    v_cmp_gt_u32 vcc, 2, v30
    v_lshl_add_u32 v8, v3, 5, v8
    v_fma_f32 v176, v176, v52, v44
    v_fma_f32 v177, v177, v53, v45
    v_fma_f32 v178, v178, v54, v46
    v_fma_f32 v179, v179, v55, v47
    v_fma_f32 v180, v180, v56, v48
    v_fma_f32 v181, v181, v57, v49
    v_fma_f32 v182, v182, v58, v50
    v_fma_f32 v183, v183, v59, v51
    v_cndmask_b32_e64 v8, v25, v8, vcc
    v_cvt_pk_bf16_f32 v88, v176, v177
    v_cvt_pk_bf16_f32 v89, v178, v179
    v_cvt_pk_bf16_f32 v90, v180, v181
    v_cvt_pk_bf16_f32 v91, v182, v183
    v_lshlrev_b32_e64 v176, 16, v88
    v_and_b32 v177, 0xffff0000, v88
    v_lshlrev_b32_e64 v178, 16, v89
    v_and_b32 v179, 0xffff0000, v89
    v_lshlrev_b32_e64 v180, 16, v90
    v_and_b32 v181, 0xffff0000, v90
    v_lshlrev_b32_e64 v182, 16, v91
    v_and_b32 v183, 0xffff0000, v91
    v_permlane32_swap_b32 v88, v90
    v_permlane32_swap_b32 v89, v91
    buffer_store_dwordx4 v[88:91], v8, s[12:15], s62 offen sc1
    v_add3_u32 v26, v88, v89, s59
    v_add3_u32 v26, v26, v90, v91
    buffer_store_dword v26, v8, s[12:15], s62 offen offset:16 sc1
    v_mul_f32 v176, v176, v60
    v_mul_f32 v177, v177, v61
    v_mul_f32 v178, v178, v62
    v_mul_f32 v179, v179, v63
    v_mul_f32 v180, v180, v64
    v_mul_f32 v181, v181, v65
    v_mul_f32 v182, v182, v66
    v_mul_f32 v183, v183, v67
    buffer_store_dwordx4 v[84:87], v8, s[12:15], s63 offen sc1
    v_cvt_pk_bf16_f32 v92, v176, v177
    v_cvt_pk_bf16_f32 v93, v178, v179
    v_cvt_pk_bf16_f32 v94, v180, v181
    v_cvt_pk_bf16_f32 v95, v182, v183
    v_lshlrev_b32_e64 v176, 16, v92
    v_and_b32 v177, 0xffff0000, v92
    v_lshlrev_b32_e64 v178, 16, v93
    v_and_b32 v179, 0xffff0000, v93
    v_lshlrev_b32_e64 v180, 16, v94
    v_and_b32 v181, 0xffff0000, v94
    v_lshlrev_b32_e64 v182, 16, v95
    v_and_b32 v183, 0xffff0000, v95
    buffer_store_dword v9, v8, s[12:15], s63 offen offset:16 sc1
    v_add_f32 v176, v176, v68
    v_add_f32 v177, v177, v69
    v_add_f32 v178, v178, v70
    v_add_f32 v179, v179, v71
    v_add_f32 v180, v180, v72
    v_add_f32 v181, v181, v73
    v_add_f32 v182, v182, v74
    v_add_f32 v183, v183, v75
    v_cvt_pk_bf16_f32 v92, v176, v177
    v_cvt_pk_bf16_f32 v93, v178, v179
    v_cvt_pk_bf16_f32 v94, v180, v181
    v_cvt_pk_bf16_f32 v95, v182, v183
    s_nop 0
    v_permlane32_swap_b32 v92, v94
    v_permlane32_swap_b32 v93, v95
    ds_write_b128 v11, v[92:95]
    v_bfe_u32 v30, v1, 2, 2
    v_lshl_add_u32 v30, v3, 3, v30
    v_lshlrev_b32 v30, 5, v30
    v_and_b32_e64 v31, 3, v1
    v_lshl_add_u32 v30, v31, 3, v30
    v_bfe_u32 v31, v1, 4, 1
    v_mul_i32_i24 v31, 16384, v31
    s_lshl_b32 s62, s54, 11
    s_add_u32 s62, s62, 98304
    v_add3_u32 v30, v30, v31, s62
    ds_read_b64_tr_b16 v[112:113], v30 offset:0
    ds_read_b64_tr_b16 v[114:115], v30 offset:128
    ds_read_b64_tr_b16 v[116:117], v30 offset:512
    ds_read_b64_tr_b16 v[118:119], v30 offset:640
    ds_read_b64_tr_b16 v[120:121], v30 offset:1024
    ds_read_b64_tr_b16 v[122:123], v30 offset:1152
    ds_read_b64_tr_b16 v[124:125], v30 offset:1536
    ds_read_b64_tr_b16 v[126:127], v30 offset:1664
    v_bfe_u32 v30, v1, 2, 2
    v_lshl_add_u32 v30, v3, 3, v30
    v_lshlrev_b32 v30, 10, v30
    v_and_b32 v31, 0x3f, v14
    s_lshl_b32 s62, s54, 7
    s_add_u32 s62, s62, 81920
    v_add3_u32 v30, v30, v31, s62
    ds_read_b64_tr_b16 v[128:129], v30 offset:0
    ds_read_b64_tr_b16 v[130:131], v30 offset:4096
    ds_read_b64_tr_b16 v[132:133], v30 offset:64
    ds_read_b64_tr_b16 v[134:135], v30 offset:4160
    s_cmp_lg_u32 s54, 7
    s_cbranch_scc1 L_kwait
    s_lshl_b32 s64, s101, 12
    s_add_u32 s64, s64, 0x8000
    v_lshlrev_b32_e64 v30, 6, v1
    s_mov_b32 s68, 0
L_kpoll:
    buffer_load_dwordx4 v[24:27], v30, s[12:15], s64 offen sc1
    s_waitcnt vmcnt(0)
    v_cmp_ne_u32 vcc, s59, v25
    v_cmp_ne_u32 s[62:63], s59, v27
    s_nop 0
    s_or_b64 vcc, vcc, s[62:63]
    s_cmp_eq_u64 vcc, 0
    s_cbranch_scc1 L_kdone
    s_add_u32 s68, s68, 1
    s_cmp_lt_u32 s68, 400000
    s_sleep 2
    s_cbranch_scc1 L_kpoll
L_kdone:
    v_mov_b32_e64 v28, v24
    s_nop 1
    v_max_u32_dpp v28, v28, v28 quad_perm:[1,0,3,2] row_mask:0xf bank_mask:0xf
    s_nop 1
    v_max_u32_dpp v28, v28, v28 quad_perm:[2,3,0,1] row_mask:0xf bank_mask:0xf
    s_nop 1
    v_max_u32_dpp v28, v28, v28 row_half_mirror row_mask:0xf bank_mask:0xf
    s_nop 1
    v_max_u32_dpp v28, v28, v28 row_mirror row_mask:0xf bank_mask:0xf
    v_mov_b32 v25, v28
    s_nop 1
    v_permlane16_swap_b32 v25, v28
    v_max_u32 v28, v28, v25
    v_mov_b32 v25, v28
    s_nop 1
    v_permlane32_swap_b32 v25, v28
    v_max_u32 v28, v28, v25
    v_cmp_eq_u32 vcc, v28, v24
    s_nop 1
    v_cndmask_b32_e64 v29, v24, v26, vcc
    s_nop 1
    v_max_u32_dpp v29, v29, v29 quad_perm:[1,0,3,2] row_mask:0xf bank_mask:0xf
    s_nop 1
    v_max_u32_dpp v29, v29, v29 quad_perm:[2,3,0,1] row_mask:0xf bank_mask:0xf
    s_nop 1
    v_max_u32_dpp v29, v29, v29 row_half_mirror row_mask:0xf bank_mask:0xf
    s_nop 1
    v_max_u32_dpp v29, v29, v29 row_mirror row_mask:0xf bank_mask:0xf
    v_mov_b32 v25, v29
    s_nop 1
    v_permlane16_swap_b32 v25, v29
    v_max_u32 v29, v29, v25
    v_mov_b32 v25, v29
    s_nop 1
    v_permlane32_swap_b32 v25, v29
    v_max_u32_e64 v29, v29, v25
    v_mov_b32 v25, 58368
    ds_write_b64 v25, v[28:29]
    s_cmp_ge_u32 s3, 14
    s_cbranch_scc1 L_kwait
    v_readfirstlane_b32 s62, v28
    s_nop 0
    s_bfe_u32 s63, s62, 0x60006
    s_sub_u32 s63, 63, s63
    s_lshl_b32 s63, s63, 1
    s_and_b32 s62, s62, 1
    s_add_u32 s63, s63, s62
    s_lshl_b32 s63, s63, 11
    s_add_u32 s63, s63, 0x60000
    s_mov_b32 m0, 73728
    s_nop 0
    buffer_load_dwordx4 v2, s[12:15], s63 offen sc1 lds
    buffer_load_dwordx4 v2, s[12:15], s63 offen offset:1024 sc1 lds
    v_readfirstlane_b32 s62, v29
    s_nop 0
    s_bfe_u32 s63, s62, 0x60006
    s_sub_u32 s63, 63, s63
    s_lshl_b32 s63, s63, 1
    s_and_b32 s62, s62, 1
    s_add_u32 s63, s63, s62
    s_lshl_b32 s63, s63, 11
    s_add_u32 s63, s63, 0x60000
    s_mov_b32 m0, 75776
    s_nop 0
    buffer_load_dwordx4 v2, s[12:15], s63 offen sc1 lds
    buffer_load_dwordx4 v2, s[12:15], s63 offen offset:1024 sc1 lds
    s_waitcnt vmcnt(0)
L_kwait:
    v_and_b32 v26, 1, v1
    v_lshlrev_b32_e64 v26, 11, v26
    v_lshl_add_u32 v26, v3, 5, v26
    s_lshl_b32 s62, s54, 8
    s_add_u32 s62, s62, 73728
    v_add_u32 v26, s62, v26
    v_and_b32 v27, 1, v1
    v_lshlrev_b32 v27, 2, v27
    v_mov_b32 v20, 58368
    s_waitcnt lgkmcnt(0)
    s_barrier
    ds_read_b128 v[136:139], v26 offset:0
    ds_read_b128 v[140:143], v26 offset:64
    ds_read_b128 v[144:147], v26 offset:128
    ds_read_b128 v[148:151], v26 offset:192
    ds_read2_b32 v[40:41], v26 offset0:4 offset1:20
    ds_read2_b32 v[42:43], v26 offset0:36 offset1:52
    ds_read_b64 v[18:19], v20
    ds_read_b128 v[92:95], v15
    s_cmp_ge_u32 s3, 14
    s_cbranch_scc1 L_notffn
    s_mov_b32 s68, 0
    s_branch L_hgo
L_hpoll:
    s_waitcnt lgkmcnt(1)
    v_readfirstlane_b32 s62, v18
    s_nop 0
    s_bfe_u32 s63, s62, 0x60006
    s_sub_u32 s63, 63, s63
    s_lshl_b32 s63, s63, 1
    s_and_b32 s62, s62, 1
    s_add_u32 s63, s63, s62
    s_lshl_b32 s63, s63, 11
    s_add_u32 s63, s63, 0x60000
    s_mov_b32 m0, 73728
    s_nop 0
    buffer_load_dwordx4 v2, s[12:15], s63 offen sc1 lds
    buffer_load_dwordx4 v2, s[12:15], s63 offen offset:1024 sc1 lds
    v_readfirstlane_b32 s62, v19
    s_nop 0
    s_bfe_u32 s63, s62, 0x60006
    s_sub_u32 s63, 63, s63
    s_lshl_b32 s63, s63, 1
    s_and_b32 s62, s62, 1
    s_add_u32 s63, s63, s62
    s_lshl_b32 s63, s63, 11
    s_add_u32 s63, s63, 0x60000
    s_mov_b32 m0, 75776
    s_nop 0
    buffer_load_dwordx4 v2, s[12:15], s63 offen sc1 lds
    buffer_load_dwordx4 v2, s[12:15], s63 offen offset:1024 sc1 lds
    s_waitcnt vmcnt(0)
    ds_read_b128 v[136:139], v26 offset:0
    ds_read_b128 v[140:143], v26 offset:64
    ds_read_b128 v[144:147], v26 offset:128
    ds_read_b128 v[148:151], v26 offset:192
    ds_read2_b32 v[40:41], v26 offset0:4 offset1:20
    ds_read2_b32 v[42:43], v26 offset0:36 offset1:52
L_hgo:
    s_waitcnt lgkmcnt(5)
    v_mfma_f32_32x32x16_bf16 v[176:191], v[136:139], v[112:115], 0
    v_add3_u32 v44, v136, v137, s59
    v_add3_u32 v44, v44, v138, v139
    s_waitcnt lgkmcnt(4)
    v_mfma_f32_32x32x16_bf16 v[176:191], v[140:143], v[116:119], v[176:191]
    v_add3_u32 v45, v140, v141, s59
    v_add3_u32 v45, v45, v142, v143
    s_waitcnt lgkmcnt(3)
    v_mfma_f32_32x32x16_bf16 v[176:191], v[144:147], v[120:123], v[176:191]
    v_add3_u32 v46, v144, v145, s59
    v_add3_u32 v46, v46, v146, v147
    s_waitcnt lgkmcnt(2)
    v_mfma_f32_32x32x16_bf16 v[176:191], v[148:151], v[124:127], v[176:191]
    v_add3_u32 v47, v148, v149, s59
    v_add3_u32 v47, v47, v150, v151
    s_waitcnt lgkmcnt(1)
    v_cmp_ne_u64_e64 vcc, v[44:45], v[40:41]
    s_waitcnt lgkmcnt(0)
    v_cmp_ne_u64 s[62:63], v[46:47], v[42:43]
    s_nop 0
    s_or_b64 vcc, vcc, s[62:63]
    s_cmp_eq_u64 vcc, 0
    s_cbranch_scc1 L_hdone
    s_add_u32 s68, s68, 1
    s_cmp_lt_u32 s68, 400000
    s_sleep 2
    s_cbranch_scc1 L_hpoll
L_hdone:
    s_lshl_b32 s62, s54, 8
    v_lshl_add_u32 v28, v4, 3, s62
    ds_write_b64 v28, v[176:177] offset:49152
    v_bfe_u32 v29, v1, 4, 1
    v_lshlrev_b32_e64 v28, 3, v23
    v_lshl_add_u32 v28, v29, 2, v28
    v_add_u32 v28, 49152, v28
    s_waitcnt lgkmcnt(0)
    s_barrier
    ds_read2_b32 v[48:49], v28 offset0:0 offset1:32
    v_add_u32 v30, 1024, v28
    ds_read2_b32 v[50:51], v28 offset0:64 offset1:96
    ds_read2_b32 v[52:53], v28 offset0:128 offset1:160
    ds_read2_b32 v[54:55], v28 offset0:192 offset1:224
    ds_read2_b32 v[56:57], v30 offset0:0 offset1:32
    ds_read2_b32 v[58:59], v30 offset0:64 offset1:96
    ds_read2_b32 v[60:61], v30 offset0:128 offset1:160
    ds_read2_b32 v[62:63], v30 offset0:192 offset1:224
    s_waitcnt lgkmcnt(6)
    v_add_f32 v48, v48, v50
    v_add_f32 v49, v49, v51
    s_waitcnt lgkmcnt(4)
    v_add_f32 v52, v52, v54
    v_add_f32 v53, v53, v55
    s_waitcnt lgkmcnt(2)
    v_add_f32 v56, v56, v58
    v_add_f32 v57, v57, v59
    s_waitcnt lgkmcnt(0)
    v_add_f32 v60, v60, v62
    v_add_f32 v61, v61, v63
    v_add_f32 v48, v48, v52
    v_add_f32 v49, v49, v53
    v_add_f32 v56, v56, v60
    v_add_f32 v57, v57, v61
    v_add_f32 v48, v48, v56
    v_add_f32 v49, v49, v57
    v_cvt_pk_bf16_f32 v50, v48, v49
    v_lshlrev_b32_e64 v48, 16, v50
    v_and_b32 v49, 0xffff0000, v50
    s_mov_b32 s62, 0xbfb8aa3b
    v_mul_f32 v50, s62, v48
    v_exp_f32 v50, v50
    s_nop 0
    v_add_f32 v50, 1.0, v50
    v_rcp_f32 v50, v50
    s_nop 0
    v_mul_f32_e64 v48, v48, v50
    v_cvt_pk_bf16_f32 v48, v48, v48
    v_lshlrev_b32 v48, 16, v48
    v_mul_f32 v48, v48, v49
    v_cvt_pk_bf16_f32 v48, v48, v48
    s_lshl_b32 s62, s54, 6
    s_add_u32 s62, s62, 53248
    v_lshl_add_u32 v28, v4, 1, s62
    ds_write_b16 v28, v48
    v_and_b32 v29, 1, v1
    v_lshlrev_b32_e64 v29, 5, v29
    v_lshl_add_u32 v29, v3, 4, v29
    v_add_u32_e64 v29, s62, v29
    ds_read_b128 v[52:55], v29
    s_waitcnt lgkmcnt(0)
    v_mfma_f32_32x32x16_bf16 v[144:159], v[52:55], v[128:131], 0
    v_mfma_f32_32x32x16_bf16 v[160:175], v[52:55], v[132:135], 0
    v_cmp_eq_u32_e64 vcc, 0, v3
    s_lshl_b32 s62, s100, 7
    s_mul_i32 s63, s54, 115712
    s_add_u32 s62, s62, s63
    v_lshrrev_b32 v60, 3, v1
    v_mul_u32_u24 v60, 14464, v60
    v_and_b32 v61, 0x70, v2
    v_add_u32_e64 v60, v60, v61
    s_add_u32 s62, s62, 0x900000
    s_nop 2
    v_cndmask_b32 v56, v160, v144, vcc
    v_cndmask_b32_e64 v57, v161, v145, vcc
    v_add3_u32 v58, v56, v57, s59
    buffer_store_dwordx4 v[56:59], v60, s[12:15], s62 offen sc1
    s_lshl_b32 s62, s61, 5
    s_sub_u32 s62, 2047, s62
    v_sub_u32 v13, s62, v13
    v_bfe_u32 v18, v18, 1, 11
    v_bfe_u32 v19, v19, 1, 11
    v_cmp_eq_u32_e64 vcc, v13, v18
    v_cmp_eq_u32 s[62:63], v13, v19
    v_mov_b32 v20, 0x7ffffff0
    s_or_b64 vcc, vcc, s[62:63]
    v_cndmask_b32 v10, v10, v20, vcc
    buffer_store_dwordx4 v[92:95], v10, s[44:47], s1 offen sc1
    s_branch L_fin
L_notffn:
    s_waitcnt lgkmcnt(0)
    ds_read_b32 v24, v27 offset:58368
    s_lshl_b32 s62, s61, 5
    s_sub_u32 s62, 2047, s62
    v_sub_u32 v13, s62, v13
    v_bfe_u32 v18, v18, 1, 11
    v_bfe_u32 v19, v19, 1, 11
    v_cmp_eq_u32_e64 vcc, v13, v18
    v_cmp_eq_u32 s[62:63], v13, v19
    v_mov_b32 v20, 0x7ffffff0
    s_or_b64 vcc, vcc, s[62:63]
    v_cndmask_b32 v10, v10, v20, vcc
    buffer_store_dwordx4 v[92:95], v10, s[44:47], s1 offen sc1
    s_cmp_ge_u32 s3, 22
    s_cbranch_scc1 L_fin
    s_waitcnt lgkmcnt(0)
    v_bfe_u32 v25, v24, 1, 11
    v_sub_u32 v25, 2047, v25
    v_lshrrev_b32 v26, 5, v25
    v_and_b32_e64 v27, 1, v24
    v_lshl_add_u32 v26, v26, 1, v27
    v_lshlrev_b32_e64 v26, 11, v26
    s_lshl_b32 s66, s101, 3
    s_add_u32 s66, s66, s3
    s_sub_u32 s66, s66, 14
    s_cmp_lg_u32 s54, 7
    s_cbranch_scc1 L_ypoll0
    s_lshl_b32 s64, s66, 5
    s_add_u32 s65, s64, 0xa0000
    s_add_u32 s64, s64, 0x60000
    s_lshl_b32 s67, s66, 5
    s_add_u32 s67, s67, 0xe1800
    v_bfe_u32 v28, v1, 1, 3
    v_lshlrev_b32_e64 v29, 2, v28
    s_mov_b32 s68, 0
L_rpoll:
    buffer_load_dwordx4 v[48:51], v26, s[12:15], s64 offen sc1
    buffer_load_dword v40, v26, s[12:15], s64 offen offset:16 sc1
    buffer_load_dwordx4 v[52:55], v26, s[12:15], s65 offen sc1
    buffer_load_dword v41, v26, s[12:15], s65 offen offset:16 sc1
    s_waitcnt vmcnt(3)
    v_add3_u32 v44, v48, v49, s59
    v_add3_u32 v44, v44, v50, v51
    s_waitcnt vmcnt(2)
    v_cmp_ne_u32 vcc, v44, v40
    s_waitcnt vmcnt(1)
    v_add3_u32 v44, v52, v53, s59
    v_add3_u32 v44, v44, v54, v55
    s_waitcnt vmcnt(0)
    v_cmp_ne_u32 s[62:63], v44, v41
    s_nop 0
    s_or_b64 vcc, vcc, s[62:63]
    s_cmp_eq_u64 vcc, 0
    s_cbranch_scc1 L_rdone
    s_add_u32 s68, s68, 1
    s_cmp_lt_u32 s68, 400000
    s_sleep 4
    s_cbranch_scc1 L_rpoll
L_rdone:
    s_add_u32 s62, s67, 0
    buffer_load_dword v72, v29, s[12:15], s62 offen sc1
    s_add_u32 s62, s67, 8192
    buffer_load_dword v73, v29, s[12:15], s62 offen sc1
    s_add_u32 s62, s67, 16384
    buffer_load_dword v74, v29, s[12:15], s62 offen sc1
    s_add_u32 s62, s67, 24576
    buffer_load_dword v75, v29, s[12:15], s62 offen sc1
    s_add_u32 s62, s67, 32768
    buffer_load_dword v76, v29, s[12:15], s62 offen sc1
    s_add_u32 s62, s67, 40960
    buffer_load_dword v77, v29, s[12:15], s62 offen sc1
    s_add_u32 s62, s67, 49152
    buffer_load_dword v78, v29, s[12:15], s62 offen sc1
    s_add_u32 s62, s67, 57344
    buffer_load_dword v79, v29, s[12:15], s62 offen sc1
    v_lshrrev_b32 v30, 1, v28
    v_mov_b32 v60, v48
    v_cmp_eq_u32 vcc, 1, v30
    s_nop 1
    v_cndmask_b32 v60, v60, v49, vcc
    v_cmp_eq_u32 vcc, 2, v30
    s_nop 1
    v_cndmask_b32 v60, v60, v50, vcc
    v_cmp_eq_u32 vcc, 3, v30
    s_nop 1
    v_cndmask_b32 v60, v60, v51, vcc
    v_mov_b32 v61, v52
    v_cmp_eq_u32 vcc, 1, v30
    s_nop 1
    v_cndmask_b32 v61, v61, v53, vcc
    v_cmp_eq_u32 vcc, 2, v30
    s_nop 1
    v_cndmask_b32 v61, v61, v54, vcc
    v_cmp_eq_u32 vcc, 3, v30
    s_nop 1
    v_cndmask_b32 v61, v61, v55, vcc
    v_and_b32 v30, 1, v28
    v_cmp_eq_u32 vcc, 1, v30
    v_lshlrev_b32_e64 v62, 16, v60
    v_and_b32 v60, 0xffff0000, v60
    v_cndmask_b32 v60, v62, v60, vcc
    v_lshlrev_b32 v62, 16, v61
    v_and_b32 v61, 0xffff0000, v61
    v_cndmask_b32_e64 v61, v62, v61, vcc
    v_and_b32 v24, 0xfffff000, v24
    v_ashrrev_i32 v30, 31, v24
    v_not_b32 v30, v30
    v_or_b32 v30, 0x80000000, v30
    v_xor_b32_e64 v24, v24, v30
    v_cvt_pk_bf16_f32 v24, v24, v24
    v_lshlrev_b32_e64 v24, 16, v24
    s_mov_b32 s62, 0xbfb8aa3b
    v_mul_f32 v24, s62, v24
    v_exp_f32 v24, v24
    s_nop 0
    v_add_f32 v24, 1.0, v24
    v_rcp_f32 v24, v24
    s_nop 0
    v_cvt_pk_bf16_f32 v24, v24, v24
    v_lshlrev_b32 v24, 16, v24
    s_waitcnt vmcnt(7)
    v_and_b32 v72, 0xfffff000, v72
    s_waitcnt vmcnt(6)
    v_and_b32 v73, 0xfffff000, v73
    s_waitcnt vmcnt(5)
    v_and_b32 v74, 0xfffff000, v74
    s_waitcnt vmcnt(4)
    v_and_b32 v75, 0xfffff000, v75
    s_waitcnt vmcnt(3)
    v_and_b32 v76, 0xfffff000, v76
    s_waitcnt vmcnt(2)
    v_and_b32 v77, 0xfffff000, v77
    s_waitcnt vmcnt(1)
    v_and_b32 v78, 0xfffff000, v78
    s_waitcnt vmcnt(0)
    v_and_b32 v79, 0xfffff000, v79
    v_add_f32 v72, v72, v74
    v_add_f32 v76, v76, v78
    v_add_f32 v72, v72, v76
    v_add_f32 v73, v73, v75
    v_add_f32 v77, v77, v79
    v_add_f32 v73, v73, v77
    v_add_f32 v56, v72, v73
    v_cvt_pk_bf16_f32 v56, v56, v56
    v_lshlrev_b32 v56, 16, v56
    v_lshlrev_b32 v25, 10, v25
    v_lshl_add_u32 v25, v28, 1, v25
    v_mov_b32 v30, 0x7ffffff0
    v_cmp_gt_u32 vcc, 16, v1
    s_nop 1
    v_cndmask_b32 v25, v30, v25, vcc
    v_lshlrev_b32_e64 v29, 2, v23
    s_barrier
    ds_read_b32 v64, v29 offset:0
    ds_read_b32 v65, v29 offset:64
    ds_read_b32 v66, v29 offset:128
    ds_read_b32 v67, v29 offset:192
    ds_read_b32 v68, v29 offset:256
    ds_read_b32 v69, v29 offset:320
    ds_read_b32 v70, v29 offset:384
    s_waitcnt lgkmcnt(5)
    v_add_f32 v64, v64, v65
    s_waitcnt lgkmcnt(4)
    v_add_f32 v64, v64, v66
    s_waitcnt lgkmcnt(3)
    v_add_f32 v64, v64, v67
    s_waitcnt lgkmcnt(2)
    v_add_f32 v64, v64, v68
    s_waitcnt lgkmcnt(1)
    v_add_f32 v64, v64, v69
    s_waitcnt lgkmcnt(0)
    v_add_f32 v64, v64, v70
    v_cvt_pk_bf16_f32 v64, v64, v64
    v_lshlrev_b32 v64, 16, v64
    v_mul_f32 v64, v64, v24
    v_cvt_pk_bf16_f32 v64, v64, v64
    v_lshlrev_b32 v64, 16, v64
    v_add_f32 v64, v64, v60
    v_cvt_pk_bf16_f32 v64, v64, v64
    v_lshlrev_b32 v64, 16, v64
    v_mul_f32 v64, v64, v56
    v_cvt_pk_bf16_f32 v64, v64, v64
    v_lshlrev_b32 v64, 16, v64
    v_add_f32 v64, v64, v61
    v_cvt_pk_bf16_f32 v64, v64, v64
    s_lshl_b32 s62, s66, 4
    buffer_store_short v64, v25, s[44:47], s62 offen sc1
    s_cmp_lg_u32 s66, 0
    s_cbranch_scc1 L_fin
    v_mov_b32 v64, s59
    v_mov_b32_e64 v65, 0
    buffer_store_dword v64, v65, s[12:15], 0 offen sc1
    s_branch L_fin
L_ypoll0:
    v_and_b32_e64 v29, 7, v1
    s_lshl_b32 s64, s54, 11
    s_mul_i32 s62, s66, 14464
    s_add_u32 s64, s64, s62
    s_add_u32 s64, s64, 0x900000
    s_mov_b32 s68, 0
L_ypoll:
    buffer_load_dwordx4 v[48:51], v2, s[12:15], s64 offen sc1
    buffer_load_dwordx4 v[52:55], v2, s[12:15], s64 offen offset:1024 sc1
    s_waitcnt vmcnt(1)
    v_add3_u32 v44, v48, v49, s59
    v_cmp_ne_u32_e64 vcc, v44, v50
    s_waitcnt vmcnt(0)
    v_add3_u32 v44, v52, v53, s59
    v_cmp_ne_u32 s[62:63], v44, v54
    s_nop 0
    s_or_b64 vcc, vcc, s[62:63]
    s_cmp_eq_u64 vcc, 0
    s_cbranch_scc1 L_ydone
    s_add_u32 s68, s68, 1
    s_cmp_lt_u32 s68, 400000
    s_sleep 1
    s_cbranch_scc1 L_ypoll
L_ydone:
    v_add_f32 v48, v48, v52
    v_add_f32 v49, v49, v53
    s_nop 0
    v_add_f32_dpp v48, v48, v48 row_ror:8 row_mask:0xf bank_mask:0xf
    v_add_f32_dpp v49, v49, v49 row_ror:8 row_mask:0xf bank_mask:0xf
    v_mov_b32 v50, v48
    v_mov_b32 v51, v49
    s_nop 0
    v_permlane16_swap_b32 v50, v48
    v_permlane16_swap_b32 v51, v49
    v_add_f32 v48, v48, v50
    v_add_f32 v49, v49, v51
    v_mov_b32 v50, v48
    v_mov_b32 v51, v49
    s_nop 0
    v_permlane32_swap_b32 v50, v48
    v_permlane32_swap_b32 v51, v49
    v_add_f32 v48, v48, v50
    v_add_f32_e64 v49, v49, v51
    s_lshl_b32 s62, s54, 6
    v_lshl_add_u32 v29, v29, 3, s62
    ds_write_b64 v29, v[48:49]
    s_waitcnt lgkmcnt(0)
    s_barrier
L_fin:
L_end:
    s_endpgm
L_t_2:
    s_waitcnt lgkmcnt(0)
    s_nop 7
    s_lshl_b32 s69, s54, 10
    s_add_u32 m0, s69, 147456
    s_nop 0
    buffer_load_dwordx4 v28, s[4:7], s10 offen lds
    s_cmp_lg_u32 s54, 7
    s_cbranch_scc1 L_wr_17
    s_mov_b32 m0, 155648
    s_nop 0
    buffer_load_dword v29, s[28:31], s11 offen lds
L_wr_17:
    s_waitcnt vmcnt(0) lgkmcnt(0)
    s_barrier
    ds_read_b128 v[144:147], v8 offset:5120
    ds_read_b128 v[140:143], v8 offset:4096
    ds_read_b128 v[152:155], v8 offset:3072
    s_cmp_lg_u32 s54, 0
    s_cbranch_scc1 L_ft_18
    buffer_load_dword v20, v30, s[32:35], s8 offen
    buffer_load_dword v21, v30, s[36:39], s8 offen
    buffer_load_dword v15, v31, s[40:43], s9 offen
L_ft_18:
    ds_read2st64_b32 v[224:225], v18 offset0:0 offset1:8
    ds_read2st64_b32 v[226:227], v7 offset0:0 offset1:16
    ds_read2st64_b32 v[228:229], v18 offset0:16 offset1:24
    ds_read2st64_b32 v[230:231], v7 offset0:32 offset1:48
    ds_read_b128 v[148:151], v8 offset:2048
    s_waitcnt lgkmcnt(3)
    v_add3_u32 v24, v224, v225, v226
    s_waitcnt lgkmcnt(2)
    v_add3_u32 v24, v24, v227, v228
    s_waitcnt lgkmcnt(1)
    v_add3_u32 v24, v24, v229, v230
    v_add3_u32 v24, v24, v231, v11
    s_nop 1
    v_add_u32_dpp v24, v24, v24 quad_perm:[1,0,3,2] row_mask:0xf bank_mask:0xf
    s_waitcnt lgkmcnt(0)
    s_nop 7
    s_branch L_u_3
L_t_6:
    s_waitcnt lgkmcnt(0)
    s_nop 7
    v_add_u32_dpp v24, v24, v24 quad_perm:[2,3,0,1] row_mask:0xf bank_mask:0xf
    s_nop 1
    v_add_u32_dpp v24, v24, v24 row_half_mirror row_mask:0xf bank_mask:0xf
    s_nop 1
    v_add_u32_dpp v24, v24, v24 row_mirror row_mask:0xf bank_mask:0xf
    v_mov_b32 v25, 161792
    s_mov_b64 exec, s[18:19]
    ds_add_u32 v25, v24
    s_mov_b64 exec, -1
    ds_read_b128 v[144:147], v8 offset:1024
    ds_read_b128 v[140:143], v8 offset:0
    s_waitcnt lgkmcnt(0)
    s_nop 7
    s_branch L_u_7
L_t_8:
    s_waitcnt lgkmcnt(0)
    s_nop 7
    s_add_u32 m0, s23, 0
    s_add_u32 s69, s22, 131072
    buffer_load_dwordx4 v16, s[24:27], s69 offen lds
    s_add_u32 m0, s23, 1024
    s_add_u32 s69, s22, 139264
    buffer_load_dwordx4 v16, s[24:27], s69 offen lds
    s_add_u32 m0, s23, 2048
    s_add_u32 s69, s22, 147456
    buffer_load_dwordx4 v16, s[24:27], s69 offen lds
    s_add_u32 m0, s23, 3072
    s_add_u32 s69, s22, 155648
    buffer_load_dwordx4 v16, s[24:27], s69 offen lds
    s_add_u32 m0, s23, 4096
    s_add_u32 s69, s22, 163840
    buffer_load_dwordx4 v16, s[24:27], s69 offen lds
    s_add_u32 m0, s23, 5120
    s_add_u32 s69, s22, 172032
    buffer_load_dwordx4 v16, s[24:27], s69 offen lds
    s_add_u32 m0, s23, 6144
    s_add_u32 s69, s22, 180224
    buffer_load_dwordx4 v16, s[24:27], s69 offen lds
    s_add_u32 m0, s23, 7168
    s_add_u32 s69, s22, 188416
    buffer_load_dwordx4 v16, s[24:27], s69 offen lds
    s_waitcnt lgkmcnt(0)
    s_nop 7
    s_branch L_u_9
L_codeend:
L_kvredo:
    s_mov_b32 s68, 0
    s_mov_b32 s48, 0x0000ffff
L_kvr:
    s_barrier
    v_mov_b32 v24, 0
    v_mov_b32 v25, 0
    ds_write2_b64 v28, v[24:25], v[24:25] offset0:0 offset1:1
    s_sub_u32 s62, s64, 524288
    s_cmp_lt_u32 s52, 4
    s_cselect_b32 s62, s64, s62
    s_add_u32 m0, s50, 0
    s_nop 0
    buffer_load_dwordx4 v2, s[12:15], s62 offen sc1 lds
    s_add_u32 m0, s51, -1024
    s_nop 0
    buffer_load_dwordx4 v2, s[12:15], s62 offen offset:1024 sc1 lds
    s_sub_u32 s62, s64, 393216
    s_cmp_lt_u32 s52, 3
    s_cselect_b32 s62, s64, s62
    s_add_u32 m0, s50, 2048
    s_nop 0
    buffer_load_dwordx4 v2, s[12:15], s62 offen sc1 lds
    s_add_u32 m0, s51, 3072
    s_nop 0
    buffer_load_dwordx4 v2, s[12:15], s62 offen offset:1024 sc1 lds
    s_sub_u32 s62, s64, 262144
    s_cmp_lt_u32 s52, 2
    s_cselect_b32 s62, s64, s62
    s_add_u32 m0, s50, 4096
    s_nop 0
    buffer_load_dwordx4 v2, s[12:15], s62 offen sc1 lds
    s_add_u32 m0, s51, 7168
    s_nop 0
    buffer_load_dwordx4 v2, s[12:15], s62 offen offset:1024 sc1 lds
    s_sub_u32 s62, s64, 131072
    s_cmp_lt_u32 s52, 1
    s_cselect_b32 s62, s64, s62
    s_add_u32 m0, s50, 6144
    s_nop 0
    buffer_load_dwordx4 v2, s[12:15], s62 offen sc1 lds
    s_add_u32 m0, s51, 11264
    s_nop 0
    buffer_load_dwordx4 v2, s[12:15], s62 offen offset:1024 sc1 lds
    s_waitcnt vmcnt(0) lgkmcnt(0)
    s_barrier
    ds_read2st64_b32 v[224:225], v18 offset0:0 offset1:8
    ds_read2st64_b32 v[226:227], v7 offset0:0 offset1:16
    ds_read2st64_b32 v[228:229], v18 offset0:16 offset1:24
    ds_read2st64_b32 v[230:231], v7 offset0:32 offset1:48
    s_waitcnt lgkmcnt(2)
    v_add3_u32 v24, v224, v225, v226
    s_waitcnt lgkmcnt(1)
    v_add3_u32 v24, v24, v227, v228
    s_waitcnt lgkmcnt(0)
    v_add3_u32 v24, v24, v229, v230
    v_add3_u32 v24, v24, v231, v11
    s_nop 1
    v_add_u32_dpp v24, v24, v24 quad_perm:[1,0,3,2] row_mask:0xf bank_mask:0xf
    s_nop 1
    v_add_u32_dpp v24, v24, v24 quad_perm:[2,3,0,1] row_mask:0xf bank_mask:0xf
    s_nop 1
    v_add_u32_dpp v24, v24, v24 row_half_mirror row_mask:0xf bank_mask:0xf
    s_nop 1
    v_add_u32_dpp v24, v24, v24 row_mirror row_mask:0xf bank_mask:0xf
    v_mov_b32 v25, 161792
    s_mov_b64 exec, s[18:19]
    ds_add_u32 v25, v24
    s_mov_b64 exec, -1
    s_waitcnt lgkmcnt(0)
    s_barrier
    ds_read_b32 v24, v28
    s_waitcnt lgkmcnt(0)
    v_cmp_ne_u32 vcc, 0, v24
    s_nop 0
    s_cmp_eq_u64 vcc, 0
    s_cbranch_scc1 L_kvrd
    s_add_u32 s68, s68, 1
    s_cmp_lt_u32 s68, 400000
    s_sleep 4
    s_cbranch_scc1 L_kvr
    s_barrier
    v_mov_b32 v24, 0
    ds_write_b32 v28, v24
    s_waitcnt lgkmcnt(0)
L_kvrd:
L_slow:
    s_nop 15
    s_lshl_b32 s68, s52, 1
    s_add_u32 s68, s68, s55
    s_lshl_b32 s62, s55, 11
    v_add_u32 v26, s62, v9
    v_mov_b32 v24, 0xff800000
    s_nop 7
    ds_read_b128 v[140:143], v18 offset:8192
    s_waitcnt lgkmcnt(0)
    v_mfma_f32_32x32x16_bf16 v[68:83], v[140:143], v[32:35], v[52:67]
    s_nop 11
    v_max3_f32 v24, v24, v68, v69
    v_max3_f32 v24, v24, v70, v71
    v_max3_f32 v24, v24, v72, v73
    v_max3_f32 v24, v24, v74, v75
    v_max3_f32 v24, v24, v76, v77
    v_max3_f32 v24, v24, v78, v79
    v_max3_f32 v24, v24, v80, v81
    v_max3_f32 v24, v24, v82, v83
    s_cmp_lt_u32 s68, 1
    s_cbranch_scc1 L_s_20
    s_nop 7
    ds_read_b128 v[140:143], v18 offset:7168
    s_waitcnt lgkmcnt(0)
    v_mfma_f32_32x32x16_bf16 v[68:83], v[140:143], v[32:35], 0
    s_nop 11
    v_max3_f32 v24, v24, v68, v69
    v_max3_f32 v24, v24, v70, v71
    v_max3_f32 v24, v24, v72, v73
    v_max3_f32 v24, v24, v74, v75
    v_max3_f32 v24, v24, v76, v77
    v_max3_f32 v24, v24, v78, v79
    v_max3_f32 v24, v24, v80, v81
    v_max3_f32 v24, v24, v82, v83
L_s_20:
    s_cmp_lt_u32 s68, 2
    s_cbranch_scc1 L_s_21
    s_nop 7
    ds_read_b128 v[140:143], v18 offset:6144
    s_waitcnt lgkmcnt(0)
    v_mfma_f32_32x32x16_bf16 v[68:83], v[140:143], v[32:35], 0
    s_nop 11
    v_max3_f32 v24, v24, v68, v69
    v_max3_f32 v24, v24, v70, v71
    v_max3_f32 v24, v24, v72, v73
    v_max3_f32 v24, v24, v74, v75
    v_max3_f32 v24, v24, v76, v77
    v_max3_f32 v24, v24, v78, v79
    v_max3_f32 v24, v24, v80, v81
    v_max3_f32 v24, v24, v82, v83
L_s_21:
    s_cmp_lt_u32 s68, 3
    s_cbranch_scc1 L_s_22
    s_nop 7
    ds_read_b128 v[140:143], v18 offset:5120
    s_waitcnt lgkmcnt(0)
    v_mfma_f32_32x32x16_bf16 v[68:83], v[140:143], v[32:35], 0
    s_nop 11
    v_max3_f32 v24, v24, v68, v69
    v_max3_f32 v24, v24, v70, v71
    v_max3_f32 v24, v24, v72, v73
    v_max3_f32 v24, v24, v74, v75
    v_max3_f32 v24, v24, v76, v77
    v_max3_f32 v24, v24, v78, v79
    v_max3_f32 v24, v24, v80, v81
    v_max3_f32 v24, v24, v82, v83
L_s_22:
    s_cmp_lt_u32 s68, 4
    s_cbranch_scc1 L_s_23
    s_nop 7
    ds_read_b128 v[140:143], v18 offset:4096
    s_waitcnt lgkmcnt(0)
    v_mfma_f32_32x32x16_bf16 v[68:83], v[140:143], v[32:35], 0
    s_nop 11
    v_max3_f32 v24, v24, v68, v69
    v_max3_f32 v24, v24, v70, v71
    v_max3_f32 v24, v24, v72, v73
    v_max3_f32 v24, v24, v74, v75
    v_max3_f32 v24, v24, v76, v77
    v_max3_f32 v24, v24, v78, v79
    v_max3_f32 v24, v24, v80, v81
    v_max3_f32 v24, v24, v82, v83
L_s_23:
    s_cmp_lt_u32 s68, 5
    s_cbranch_scc1 L_s_24
    s_nop 7
    ds_read_b128 v[140:143], v18 offset:3072
    s_waitcnt lgkmcnt(0)
    v_mfma_f32_32x32x16_bf16 v[68:83], v[140:143], v[32:35], 0
    s_nop 11
    v_max3_f32 v24, v24, v68, v69
    v_max3_f32 v24, v24, v70, v71
    v_max3_f32 v24, v24, v72, v73
    v_max3_f32 v24, v24, v74, v75
    v_max3_f32 v24, v24, v76, v77
    v_max3_f32 v24, v24, v78, v79
    v_max3_f32 v24, v24, v80, v81
    v_max3_f32 v24, v24, v82, v83
L_s_24:
    s_cmp_lt_u32 s68, 6
    s_cbranch_scc1 L_s_25
    s_nop 7
    ds_read_b128 v[140:143], v18 offset:2048
    s_waitcnt lgkmcnt(0)
    v_mfma_f32_32x32x16_bf16 v[68:83], v[140:143], v[32:35], 0
    s_nop 11
    v_max3_f32 v24, v24, v68, v69
    v_max3_f32 v24, v24, v70, v71
    v_max3_f32 v24, v24, v72, v73
    v_max3_f32 v24, v24, v74, v75
    v_max3_f32 v24, v24, v76, v77
    v_max3_f32 v24, v24, v78, v79
    v_max3_f32 v24, v24, v80, v81
    v_max3_f32 v24, v24, v82, v83
L_s_25:
    s_cmp_lt_u32 s68, 7
    s_cbranch_scc1 L_s_26
    s_nop 7
    ds_read_b128 v[140:143], v18 offset:1024
    s_waitcnt lgkmcnt(0)
    v_mfma_f32_32x32x16_bf16 v[68:83], v[140:143], v[32:35], 0
    s_nop 11
    v_max3_f32 v24, v24, v68, v69
    v_max3_f32 v24, v24, v70, v71
    v_max3_f32 v24, v24, v72, v73
    v_max3_f32 v24, v24, v74, v75
    v_max3_f32 v24, v24, v76, v77
    v_max3_f32 v24, v24, v78, v79
    v_max3_f32 v24, v24, v80, v81
    v_max3_f32 v24, v24, v82, v83
L_s_26:
    s_cmp_lt_u32 s68, 8
    s_cbranch_scc1 L_s_27
    s_nop 7
    ds_read_b128 v[140:143], v18 offset:0
    s_waitcnt lgkmcnt(0)
    v_mfma_f32_32x32x16_bf16 v[68:83], v[140:143], v[32:35], v[36:51]
    s_nop 11
    v_max3_f32 v24, v24, v68, v69
    v_max3_f32 v24, v24, v70, v71
    v_max3_f32 v24, v24, v72, v73
    v_max3_f32 v24, v24, v74, v75
    v_max3_f32 v24, v24, v76, v77
    v_max3_f32 v24, v24, v78, v79
    v_max3_f32 v24, v24, v80, v81
    v_max3_f32 v24, v24, v82, v83
L_s_27:
    v_mov_b32 v25, v24
    s_nop 1
    v_permlane32_swap_b32 v25, v24
    v_max_f32 v24, v24, v25
    s_nop 7
    ds_read_b128 v[140:143], v18 offset:8192
    s_mov_b64 exec, s[48:49]
    ds_read_b128 v[124:127], v26 offset:16384
    ds_read_b128 v[128:131], v26 offset:17408
    s_mov_b64 exec, -1
    s_waitcnt lgkmcnt(2)
    v_mfma_f32_32x32x16_bf16 v[68:83], v[140:143], v[32:35], v[52:67]
    s_nop 11
    v_sub_f32 v68, v68, v24
    v_sub_f32 v69, v69, v24
    v_sub_f32 v70, v70, v24
    v_sub_f32 v71, v71, v24
    v_sub_f32 v72, v72, v24
    v_sub_f32 v73, v73, v24
    v_sub_f32 v74, v74, v24
    v_sub_f32 v75, v75, v24
    v_sub_f32 v76, v76, v24
    v_sub_f32 v77, v77, v24
    v_sub_f32 v78, v78, v24
    v_sub_f32 v79, v79, v24
    v_sub_f32 v80, v80, v24
    v_sub_f32 v81, v81, v24
    v_sub_f32 v82, v82, v24
    v_sub_f32 v83, v83, v24
    v_exp_f32 v68, v68
    v_exp_f32 v69, v69
    v_exp_f32 v70, v70
    v_exp_f32 v71, v71
    v_exp_f32 v72, v72
    v_exp_f32 v73, v73
    v_exp_f32 v74, v74
    v_exp_f32 v75, v75
    v_cvt_pk_bf16_f32 v116, v68, v69
    v_cvt_pk_bf16_f32 v117, v70, v71
    v_cvt_pk_bf16_f32 v118, v72, v73
    v_cvt_pk_bf16_f32 v119, v74, v75
    v_exp_f32 v76, v76
    v_exp_f32 v77, v77
    v_exp_f32 v78, v78
    v_exp_f32 v79, v79
    s_waitcnt lgkmcnt(1)
    v_mfma_f32_32x32x16_bf16 v[100:115], v[124:127], v[116:119], 0
    v_exp_f32 v80, v80
    v_exp_f32 v81, v81
    v_exp_f32 v82, v82
    v_exp_f32 v83, v83
    v_cvt_pk_bf16_f32 v120, v76, v77
    v_cvt_pk_bf16_f32 v121, v78, v79
    v_cvt_pk_bf16_f32 v122, v80, v81
    v_cvt_pk_bf16_f32 v123, v82, v83
    s_waitcnt lgkmcnt(0)
    s_nop 0
    v_mfma_f32_32x32x16_bf16 v[100:115], v[128:131], v[120:123], v[100:115]
    s_cmp_lt_u32 s68, 1
    s_cbranch_scc1 L_s_29
    s_nop 7
    ds_read_b128 v[140:143], v18 offset:7168
    s_mov_b64 exec, s[48:49]
    ds_read_b128 v[124:127], v26 offset:14336
    ds_read_b128 v[128:131], v26 offset:15360
    s_mov_b64 exec, -1
    s_waitcnt lgkmcnt(2)
    v_mfma_f32_32x32x16_bf16 v[68:83], v[140:143], v[32:35], 0
    s_nop 11
    v_sub_f32 v68, v68, v24
    v_sub_f32 v69, v69, v24
    v_sub_f32 v70, v70, v24
    v_sub_f32 v71, v71, v24
    v_sub_f32 v72, v72, v24
    v_sub_f32 v73, v73, v24
    v_sub_f32 v74, v74, v24
    v_sub_f32 v75, v75, v24
    v_sub_f32 v76, v76, v24
    v_sub_f32 v77, v77, v24
    v_sub_f32 v78, v78, v24
    v_sub_f32 v79, v79, v24
    v_sub_f32 v80, v80, v24
    v_sub_f32 v81, v81, v24
    v_sub_f32 v82, v82, v24
    v_sub_f32 v83, v83, v24
    v_exp_f32 v68, v68
    v_exp_f32 v69, v69
    v_exp_f32 v70, v70
    v_exp_f32 v71, v71
    v_exp_f32 v72, v72
    v_exp_f32 v73, v73
    v_exp_f32 v74, v74
    v_exp_f32 v75, v75
    v_cvt_pk_bf16_f32 v116, v68, v69
    v_cvt_pk_bf16_f32 v117, v70, v71
    v_cvt_pk_bf16_f32 v118, v72, v73
    v_cvt_pk_bf16_f32 v119, v74, v75
    v_exp_f32 v76, v76
    v_exp_f32 v77, v77
    v_exp_f32 v78, v78
    v_exp_f32 v79, v79
    s_waitcnt lgkmcnt(1)
    v_mfma_f32_32x32x16_bf16 v[100:115], v[124:127], v[116:119], v[100:115]
    v_exp_f32 v80, v80
    v_exp_f32 v81, v81
    v_exp_f32 v82, v82
    v_exp_f32 v83, v83
    v_cvt_pk_bf16_f32 v120, v76, v77
    v_cvt_pk_bf16_f32 v121, v78, v79
    v_cvt_pk_bf16_f32 v122, v80, v81
    v_cvt_pk_bf16_f32 v123, v82, v83
    s_waitcnt lgkmcnt(0)
    s_nop 0
    v_mfma_f32_32x32x16_bf16 v[100:115], v[128:131], v[120:123], v[100:115]
L_s_29:
    s_cmp_lt_u32 s68, 2
    s_cbranch_scc1 L_s_30
    s_nop 7
    ds_read_b128 v[140:143], v18 offset:6144
    s_mov_b64 exec, s[48:49]
    ds_read_b128 v[124:127], v26 offset:12288
    ds_read_b128 v[128:131], v26 offset:13312
    s_mov_b64 exec, -1
    s_waitcnt lgkmcnt(2)
    v_mfma_f32_32x32x16_bf16 v[68:83], v[140:143], v[32:35], 0
    s_nop 11
    v_sub_f32 v68, v68, v24
    v_sub_f32 v69, v69, v24
    v_sub_f32 v70, v70, v24
    v_sub_f32 v71, v71, v24
    v_sub_f32 v72, v72, v24
    v_sub_f32 v73, v73, v24
    v_sub_f32 v74, v74, v24
    v_sub_f32 v75, v75, v24
    v_sub_f32 v76, v76, v24
    v_sub_f32 v77, v77, v24
    v_sub_f32 v78, v78, v24
    v_sub_f32 v79, v79, v24
    v_sub_f32 v80, v80, v24
    v_sub_f32 v81, v81, v24
    v_sub_f32 v82, v82, v24
    v_sub_f32 v83, v83, v24
    v_exp_f32 v68, v68
    v_exp_f32 v69, v69
    v_exp_f32 v70, v70
    v_exp_f32 v71, v71
    v_exp_f32 v72, v72
    v_exp_f32 v73, v73
    v_exp_f32 v74, v74
    v_exp_f32 v75, v75
    v_cvt_pk_bf16_f32 v116, v68, v69
    v_cvt_pk_bf16_f32 v117, v70, v71
    v_cvt_pk_bf16_f32 v118, v72, v73
    v_cvt_pk_bf16_f32 v119, v74, v75
    v_exp_f32 v76, v76
    v_exp_f32 v77, v77
    v_exp_f32 v78, v78
    v_exp_f32 v79, v79
    s_waitcnt lgkmcnt(1)
    v_mfma_f32_32x32x16_bf16 v[100:115], v[124:127], v[116:119], v[100:115]
    v_exp_f32 v80, v80
    v_exp_f32 v81, v81
    v_exp_f32 v82, v82
    v_exp_f32 v83, v83
    v_cvt_pk_bf16_f32 v120, v76, v77
    v_cvt_pk_bf16_f32 v121, v78, v79
    v_cvt_pk_bf16_f32 v122, v80, v81
    v_cvt_pk_bf16_f32 v123, v82, v83
    s_waitcnt lgkmcnt(0)
    s_nop 0
    v_mfma_f32_32x32x16_bf16 v[100:115], v[128:131], v[120:123], v[100:115]
L_s_30:
    s_cmp_lt_u32 s68, 3
    s_cbranch_scc1 L_s_31
    s_nop 7
    ds_read_b128 v[140:143], v18 offset:5120
    s_mov_b64 exec, s[48:49]
    ds_read_b128 v[124:127], v26 offset:10240
    ds_read_b128 v[128:131], v26 offset:11264
    s_mov_b64 exec, -1
    s_waitcnt lgkmcnt(2)
    v_mfma_f32_32x32x16_bf16 v[68:83], v[140:143], v[32:35], 0
    s_nop 11
    v_sub_f32 v68, v68, v24
    v_sub_f32 v69, v69, v24
    v_sub_f32 v70, v70, v24
    v_sub_f32 v71, v71, v24
    v_sub_f32 v72, v72, v24
    v_sub_f32 v73, v73, v24
    v_sub_f32 v74, v74, v24
    v_sub_f32 v75, v75, v24
    v_sub_f32 v76, v76, v24
    v_sub_f32 v77, v77, v24
    v_sub_f32 v78, v78, v24
    v_sub_f32 v79, v79, v24
    v_sub_f32 v80, v80, v24
    v_sub_f32 v81, v81, v24
    v_sub_f32 v82, v82, v24
    v_sub_f32 v83, v83, v24
    v_exp_f32 v68, v68
    v_exp_f32 v69, v69
    v_exp_f32 v70, v70
    v_exp_f32 v71, v71
    v_exp_f32 v72, v72
    v_exp_f32 v73, v73
    v_exp_f32 v74, v74
    v_exp_f32 v75, v75
    v_cvt_pk_bf16_f32 v116, v68, v69
    v_cvt_pk_bf16_f32 v117, v70, v71
    v_cvt_pk_bf16_f32 v118, v72, v73
    v_cvt_pk_bf16_f32 v119, v74, v75
    v_exp_f32 v76, v76
    v_exp_f32 v77, v77
    v_exp_f32 v78, v78
    v_exp_f32 v79, v79
    s_waitcnt lgkmcnt(1)
    v_mfma_f32_32x32x16_bf16 v[100:115], v[124:127], v[116:119], v[100:115]
    v_exp_f32 v80, v80
    v_exp_f32 v81, v81
    v_exp_f32 v82, v82
    v_exp_f32 v83, v83
    v_cvt_pk_bf16_f32 v120, v76, v77
    v_cvt_pk_bf16_f32 v121, v78, v79
    v_cvt_pk_bf16_f32 v122, v80, v81
    v_cvt_pk_bf16_f32 v123, v82, v83
    s_waitcnt lgkmcnt(0)
    s_nop 0
    v_mfma_f32_32x32x16_bf16 v[100:115], v[128:131], v[120:123], v[100:115]
L_s_31:
    s_cmp_lt_u32 s68, 4
    s_cbranch_scc1 L_s_32
    s_nop 7
    ds_read_b128 v[140:143], v18 offset:4096
    s_mov_b64 exec, s[48:49]
    ds_read_b128 v[124:127], v26 offset:8192
    ds_read_b128 v[128:131], v26 offset:9216
    s_mov_b64 exec, -1
    s_waitcnt lgkmcnt(2)
    v_mfma_f32_32x32x16_bf16 v[68:83], v[140:143], v[32:35], 0
    s_nop 11
    v_sub_f32 v68, v68, v24
    v_sub_f32 v69, v69, v24
    v_sub_f32 v70, v70, v24
    v_sub_f32 v71, v71, v24
    v_sub_f32 v72, v72, v24
    v_sub_f32 v73, v73, v24
    v_sub_f32 v74, v74, v24
    v_sub_f32 v75, v75, v24
    v_sub_f32 v76, v76, v24
    v_sub_f32 v77, v77, v24
    v_sub_f32 v78, v78, v24
    v_sub_f32 v79, v79, v24
    v_sub_f32 v80, v80, v24
    v_sub_f32 v81, v81, v24
    v_sub_f32 v82, v82, v24
    v_sub_f32 v83, v83, v24
    v_exp_f32 v68, v68
    v_exp_f32 v69, v69
    v_exp_f32 v70, v70
    v_exp_f32 v71, v71
    v_exp_f32 v72, v72
    v_exp_f32 v73, v73
    v_exp_f32 v74, v74
    v_exp_f32 v75, v75
    v_cvt_pk_bf16_f32 v116, v68, v69
    v_cvt_pk_bf16_f32 v117, v70, v71
    v_cvt_pk_bf16_f32 v118, v72, v73
    v_cvt_pk_bf16_f32 v119, v74, v75
    v_exp_f32 v76, v76
    v_exp_f32 v77, v77
    v_exp_f32 v78, v78
    v_exp_f32 v79, v79
    s_waitcnt lgkmcnt(1)
    v_mfma_f32_32x32x16_bf16 v[100:115], v[124:127], v[116:119], v[100:115]
    v_exp_f32 v80, v80
    v_exp_f32 v81, v81
    v_exp_f32 v82, v82
    v_exp_f32 v83, v83
    v_cvt_pk_bf16_f32 v120, v76, v77
    v_cvt_pk_bf16_f32 v121, v78, v79
    v_cvt_pk_bf16_f32 v122, v80, v81
    v_cvt_pk_bf16_f32 v123, v82, v83
    s_waitcnt lgkmcnt(0)
    s_nop 0
    v_mfma_f32_32x32x16_bf16 v[100:115], v[128:131], v[120:123], v[100:115]
L_s_32:
    s_cmp_lt_u32 s68, 5
    s_cbranch_scc1 L_s_33
    s_nop 7
    ds_read_b128 v[140:143], v18 offset:3072
    s_mov_b64 exec, s[48:49]
    ds_read_b128 v[124:127], v26 offset:6144
    ds_read_b128 v[128:131], v26 offset:7168
    s_mov_b64 exec, -1
    s_waitcnt lgkmcnt(2)
    v_mfma_f32_32x32x16_bf16 v[68:83], v[140:143], v[32:35], 0
    s_nop 11
    v_sub_f32 v68, v68, v24
    v_sub_f32 v69, v69, v24
    v_sub_f32 v70, v70, v24
    v_sub_f32 v71, v71, v24
    v_sub_f32 v72, v72, v24
    v_sub_f32 v73, v73, v24
    v_sub_f32 v74, v74, v24
    v_sub_f32 v75, v75, v24
    v_sub_f32 v76, v76, v24
    v_sub_f32 v77, v77, v24
    v_sub_f32 v78, v78, v24
    v_sub_f32 v79, v79, v24
    v_sub_f32 v80, v80, v24
    v_sub_f32 v81, v81, v24
    v_sub_f32 v82, v82, v24
    v_sub_f32 v83, v83, v24
    v_exp_f32 v68, v68
    v_exp_f32 v69, v69
    v_exp_f32 v70, v70
    v_exp_f32 v71, v71
    v_exp_f32 v72, v72
    v_exp_f32 v73, v73
    v_exp_f32 v74, v74
    v_exp_f32 v75, v75
    v_cvt_pk_bf16_f32 v116, v68, v69
    v_cvt_pk_bf16_f32 v117, v70, v71
    v_cvt_pk_bf16_f32 v118, v72, v73
    v_cvt_pk_bf16_f32 v119, v74, v75
    v_exp_f32 v76, v76
    v_exp_f32 v77, v77
    v_exp_f32 v78, v78
    v_exp_f32 v79, v79
    s_waitcnt lgkmcnt(1)
    v_mfma_f32_32x32x16_bf16 v[100:115], v[124:127], v[116:119], v[100:115]
    v_exp_f32 v80, v80
    v_exp_f32 v81, v81
    v_exp_f32 v82, v82
    v_exp_f32 v83, v83
    v_cvt_pk_bf16_f32 v120, v76, v77
    v_cvt_pk_bf16_f32 v121, v78, v79
    v_cvt_pk_bf16_f32 v122, v80, v81
    v_cvt_pk_bf16_f32 v123, v82, v83
    s_waitcnt lgkmcnt(0)
    s_nop 0
    v_mfma_f32_32x32x16_bf16 v[100:115], v[128:131], v[120:123], v[100:115]
L_s_33:
    s_cmp_lt_u32 s68, 6
    s_cbranch_scc1 L_s_34
    s_nop 7
    ds_read_b128 v[140:143], v18 offset:2048
    s_mov_b64 exec, s[48:49]
    ds_read_b128 v[124:127], v26 offset:4096
    ds_read_b128 v[128:131], v26 offset:5120
    s_mov_b64 exec, -1
    s_waitcnt lgkmcnt(2)
    v_mfma_f32_32x32x16_bf16 v[68:83], v[140:143], v[32:35], 0
    s_nop 11
    v_sub_f32 v68, v68, v24
    v_sub_f32 v69, v69, v24
    v_sub_f32 v70, v70, v24
    v_sub_f32 v71, v71, v24
    v_sub_f32 v72, v72, v24
    v_sub_f32 v73, v73, v24
    v_sub_f32 v74, v74, v24
    v_sub_f32 v75, v75, v24
    v_sub_f32 v76, v76, v24
    v_sub_f32 v77, v77, v24
    v_sub_f32 v78, v78, v24
    v_sub_f32 v79, v79, v24
    v_sub_f32 v80, v80, v24
    v_sub_f32 v81, v81, v24
    v_sub_f32 v82, v82, v24
    v_sub_f32 v83, v83, v24
    v_exp_f32 v68, v68
    v_exp_f32 v69, v69
    v_exp_f32 v70, v70
    v_exp_f32 v71, v71
    v_exp_f32 v72, v72
    v_exp_f32 v73, v73
    v_exp_f32 v74, v74
    v_exp_f32 v75, v75
    v_cvt_pk_bf16_f32 v116, v68, v69
    v_cvt_pk_bf16_f32 v117, v70, v71
    v_cvt_pk_bf16_f32 v118, v72, v73
    v_cvt_pk_bf16_f32 v119, v74, v75
    v_exp_f32 v76, v76
    v_exp_f32 v77, v77
    v_exp_f32 v78, v78
    v_exp_f32 v79, v79
    s_waitcnt lgkmcnt(1)
    v_mfma_f32_32x32x16_bf16 v[100:115], v[124:127], v[116:119], v[100:115]
    v_exp_f32 v80, v80
    v_exp_f32 v81, v81
    v_exp_f32 v82, v82
    v_exp_f32 v83, v83
    v_cvt_pk_bf16_f32 v120, v76, v77
    v_cvt_pk_bf16_f32 v121, v78, v79
    v_cvt_pk_bf16_f32 v122, v80, v81
    v_cvt_pk_bf16_f32 v123, v82, v83
    s_waitcnt lgkmcnt(0)
    s_nop 0
    v_mfma_f32_32x32x16_bf16 v[100:115], v[128:131], v[120:123], v[100:115]
L_s_34:
    s_cmp_lt_u32 s68, 7
    s_cbranch_scc1 L_s_35
    s_nop 7
    ds_read_b128 v[140:143], v18 offset:1024
    s_mov_b64 exec, s[48:49]
    ds_read_b128 v[124:127], v26 offset:2048
    ds_read_b128 v[128:131], v26 offset:3072
    s_mov_b64 exec, -1
    s_waitcnt lgkmcnt(2)
    v_mfma_f32_32x32x16_bf16 v[68:83], v[140:143], v[32:35], 0
    s_nop 11
    v_sub_f32 v68, v68, v24
    v_sub_f32 v69, v69, v24
    v_sub_f32 v70, v70, v24
    v_sub_f32 v71, v71, v24
    v_sub_f32 v72, v72, v24
    v_sub_f32 v73, v73, v24
    v_sub_f32 v74, v74, v24
    v_sub_f32 v75, v75, v24
    v_sub_f32 v76, v76, v24
    v_sub_f32 v77, v77, v24
    v_sub_f32 v78, v78, v24
    v_sub_f32 v79, v79, v24
    v_sub_f32 v80, v80, v24
    v_sub_f32 v81, v81, v24
    v_sub_f32 v82, v82, v24
    v_sub_f32 v83, v83, v24
    v_exp_f32 v68, v68
    v_exp_f32 v69, v69
    v_exp_f32 v70, v70
    v_exp_f32 v71, v71
    v_exp_f32 v72, v72
    v_exp_f32 v73, v73
    v_exp_f32 v74, v74
    v_exp_f32 v75, v75
    v_cvt_pk_bf16_f32 v116, v68, v69
    v_cvt_pk_bf16_f32 v117, v70, v71
    v_cvt_pk_bf16_f32 v118, v72, v73
    v_cvt_pk_bf16_f32 v119, v74, v75
    v_exp_f32 v76, v76
    v_exp_f32 v77, v77
    v_exp_f32 v78, v78
    v_exp_f32 v79, v79
    s_waitcnt lgkmcnt(1)
    v_mfma_f32_32x32x16_bf16 v[100:115], v[124:127], v[116:119], v[100:115]
    v_exp_f32 v80, v80
    v_exp_f32 v81, v81
    v_exp_f32 v82, v82
    v_exp_f32 v83, v83
    v_cvt_pk_bf16_f32 v120, v76, v77
    v_cvt_pk_bf16_f32 v121, v78, v79
    v_cvt_pk_bf16_f32 v122, v80, v81
    v_cvt_pk_bf16_f32 v123, v82, v83
    s_waitcnt lgkmcnt(0)
    s_nop 0
    v_mfma_f32_32x32x16_bf16 v[100:115], v[128:131], v[120:123], v[100:115]
L_s_35:
    s_cmp_lt_u32 s68, 8
    s_cbranch_scc1 L_s_36
    s_nop 7
    ds_read_b128 v[140:143], v18 offset:0
    s_mov_b64 exec, s[48:49]
    ds_read_b128 v[124:127], v26 offset:0
    ds_read_b128 v[128:131], v26 offset:1024
    s_mov_b64 exec, -1
    s_waitcnt lgkmcnt(2)
    v_mfma_f32_32x32x16_bf16 v[68:83], v[140:143], v[32:35], v[36:51]
    s_nop 11
    v_sub_f32 v68, v68, v24
    v_sub_f32 v69, v69, v24
    v_sub_f32 v70, v70, v24
    v_sub_f32 v71, v71, v24
    v_sub_f32 v72, v72, v24
    v_sub_f32 v73, v73, v24
    v_sub_f32 v74, v74, v24
    v_sub_f32 v75, v75, v24
    v_sub_f32 v76, v76, v24
    v_sub_f32 v77, v77, v24
    v_sub_f32 v78, v78, v24
    v_sub_f32 v79, v79, v24
    v_sub_f32 v80, v80, v24
    v_sub_f32 v81, v81, v24
    v_sub_f32 v82, v82, v24
    v_sub_f32 v83, v83, v24
    v_exp_f32 v68, v68
    v_exp_f32 v69, v69
    v_exp_f32 v70, v70
    v_exp_f32 v71, v71
    v_exp_f32 v72, v72
    v_exp_f32 v73, v73
    v_exp_f32 v74, v74
    v_exp_f32 v75, v75
    v_cvt_pk_bf16_f32 v116, v68, v69
    v_cvt_pk_bf16_f32 v117, v70, v71
    v_cvt_pk_bf16_f32 v118, v72, v73
    v_cvt_pk_bf16_f32 v119, v74, v75
    v_exp_f32 v76, v76
    v_exp_f32 v77, v77
    v_exp_f32 v78, v78
    v_exp_f32 v79, v79
    s_waitcnt lgkmcnt(1)
    v_mfma_f32_32x32x16_bf16 v[100:115], v[124:127], v[116:119], v[100:115]
    v_exp_f32 v80, v80
    v_exp_f32 v81, v81
    v_exp_f32 v82, v82
    v_exp_f32 v83, v83
    v_cvt_pk_bf16_f32 v120, v76, v77
    v_cvt_pk_bf16_f32 v121, v78, v79
    v_cvt_pk_bf16_f32 v122, v80, v81
    v_cvt_pk_bf16_f32 v123, v82, v83
    s_waitcnt lgkmcnt(0)
    s_nop 0
    v_mfma_f32_32x32x16_bf16 v[100:115], v[128:131], v[120:123], v[100:115]
L_s_36:
    s_waitcnt lgkmcnt(0)
    s_nop 15
    s_branch L_attdone
L_oredo:
    s_waitcnt lgkmcnt(0)
    s_cmp_ge_u32 s68, 2000
    s_cbranch_scc1 L_ogo
    s_barrier
    s_mov_b32 m0, s50
    s_nop 0
    buffer_load_dwordx4 v2, s[12:15], s64 offen offset:0 sc1 lds
    buffer_load_dwordx4 v2, s[12:15], s64 offen offset:1024 sc1 lds
    buffer_load_dwordx4 v2, s[12:15], s64 offen offset:2048 sc1 lds
    buffer_load_dwordx4 v2, s[12:15], s64 offen offset:3072 sc1 lds
    s_branch L_proj
.section .rodata,"a"
.p2align 6
.amdhsa_kernel adaLN_cond__sliding_block__moe_arch_mod__prompt_kernel
  .amdhsa_next_free_vgpr 256
  .amdhsa_next_free_sgpr 102
  .amdhsa_accum_offset 256
  .amdhsa_group_segment_fixed_size 0
  .amdhsa_kernarg_size 104
  .amdhsa_user_sgpr_count 2
  .amdhsa_user_sgpr_kernarg_segment_ptr 1
  .amdhsa_system_sgpr_workgroup_id_x 1
  .amdhsa_float_denorm_mode_32 3
  .amdhsa_float_denorm_mode_16_64 3
.end_amdhsa_kernel
```
